```python
import torch

def _softmax(x, axis=-1):
    return torch.softmax(x, dim=axis)
def _gelu(x):
    return torch.nn.functional.gelu(x, approximate="tanh")
def _silu(x):
    return torch.nn.functional.silu(x)
def _sigmoid(x):
    return torch.sigmoid(x)
def _layernorm(x, axis=-1, eps=1e-5):
    m = x.mean(dim=axis, keepdim=True)
    v = x.var(dim=axis, keepdim=True, unbiased=False)
    return (x - m) / torch.sqrt(v + eps)
def _scatter_add(tgt, idx, src, axis=0):
    return tgt.clone().index_add_(axis, idx, src)
def _segment_sum(src, seg, n):
    out = torch.zeros((n,) + src.shape[1:], dtype=src.dtype)
    return out.index_add_(0, seg, src)
def _pad(x, pw):
    flat = tuple(v for pair in reversed(pw) for v in pair)
    return torch.nn.functional.pad(x, flat)

kernel_name = 'standalone__attention_interact_autoint__recsys'

def setup_inputs():

    _w = (lambda a: (lambda t: t.to(torch.bfloat16) if t.is_floating_point() else t)(torch.as_tensor(a)))
    B, F = 4096, 100
    D = max(2, (16 // 2) * 2)
    H = 2
    Dh = D // H
    return {
        "e": _w((lambda *s: torch.randn(*s, dtype=torch.bfloat16) * 0.05)(B, F, D).to(float)),
        "wq": _w((lambda *s: torch.randn(*s, dtype=torch.bfloat16) * 6.4)(H, D, Dh).to(float)),
        "wk": _w((lambda *s: torch.randn(*s, dtype=torch.bfloat16) * 6.4)(H, D, Dh).to(float)),
        "wv": _w((lambda *s: torch.randn(*s, dtype=torch.bfloat16) * 0.05)(H, D, Dh).to(float)),
        "wres": _w((lambda *s: torch.randn(*s, dtype=torch.bfloat16) * 0.05)(D, D).to(float)),
    }

def reference(e, wq, wk, wv, wres):
    H, D, Dh = wq.shape[0], wq.shape[1], wq.shape[2]
    B, F = e.shape[0], e.shape[1]
    q = torch.einsum('bfd,hdk->bhfk', e, wq)
    k = torch.einsum('bfd,hdk->bhfk', e, wk)
    v = torch.einsum('bfd,hdk->bhfk', e, wv)
    scale = float(Dh) ** -0.5
    scores = torch.einsum('bhfk,bhgk->bhfg', q, k) * scale
    attn = _softmax(scores, axis=-1)
    attn = (lambda x, dt: x.to(dt))(attn, v.dtype)
    ctx = torch.einsum('bhfg,bhgk->bhfk', attn, v)
    ctx = (lambda x, *d: x.permute(*d))(ctx, 0, 2, 1, 3).reshape(B, F, H * Dh)
    res = torch.einsum('bfd,de->bfe', e, wres)
    out = ctx + res
    mask = (lambda x, dt: x.to(dt))(out > 0, out.dtype)
    return out * mask
```

```asm
; @launch grid=(512,1,1) block=(256,1,1) lds=8192
.amdgcn_target "amdgcn-amd-amdhsa--gfx950"
.text
.globl standalone__attention_interact_autoint__recsys_kernel
.p2align 8
.type standalone__attention_interact_autoint__recsys_kernel,@function
standalone__attention_interact_autoint__recsys_kernel:
    s_cmp_ge_u32 s2, 512
    s_cbranch_scc1 L_end
    s_load_dwordx8 s[48:55], s[0:1], 0
    s_load_dwordx4 s[56:59], s[0:1], 32
    v_and_b32 v1, 31, v0
    v_bfe_u32 v2, v0, 5, 1
    v_lshrrev_b32 v204, 6, v0
    s_nop 0
    v_readfirstlane_b32 s29, v204
    v_lshlrev_b32 v205, 4, v2
    v_lshl_add_u32 v3, v1, 5, v205
    v_and_b32 v204, 3, v1
    v_lshl_add_u32 v4, v204, 5, v205
    v_lshlrev_b32 v205, 3, v2
    v_lshl_add_u32 v5, v1, 5, v205
    v_and_b32 v204, 27, v1
    v_mov_b32 v205, 0x3f803f80
    v_cmp_eq_u32 vcc, 16, v204
    s_nop 1
    v_cndmask_b32_e64 v6, 0, v205, vcc
    v_add_u32 v7, -1, v2
    v_sub_u32 v8, 0, v2
    s_mov_b32 s34, 0x0000ffff
    s_mov_b32 s35, 0x0000ffff
    s_mov_b32 s36, 0xffff0000
    s_mov_b32 s37, 0xffff0000
    s_mov_b32 s42, 0x000000ff
    s_mov_b32 s43, 0x000000ff
    s_mov_b32 s44, -1
    s_mov_b32 s45, 0
    s_mov_b32 s32, 0
    s_lshl_b32 s30, s2, 2
    s_add_u32 s30, s30, s29
    s_mul_i32 s28, s30, 6400
    v_bfe_u32 v206, v1, 2, 1
    v_lshlrev_b32 v206, 8, v206
    v_and_b32 v204, 3, v1
    v_bfe_u32 v205, v1, 3, 1
    v_lshl_add_u32 v204, v205, 2, v204
    v_lshl_add_u32 v206, v204, 1, v206
    v_lshl_add_u32 v206, v2, 7, v206
    v_and_b32 v204, 7, v1
    v_lshl_add_u32 v204, v205, 3, v204
    v_lshlrev_b32 v207, 1, v204
    v_lshl_add_u32 v207, v2, 8, v207
    v_and_b32 v204, 7, v1
    v_lshlrev_b32 v210, 8, v205
    v_lshl_add_u32 v210, v204, 1, v210
    v_lshl_add_u32 v210, v2, 7, v210
    v_cmp_gt_u32 vcc, 16, v1
    v_mov_b32 v204, 0x3f0293ee
    s_nop 0
    v_cndmask_b32_e64 v208, v204, 1.0, vcc
    v_cndmask_b32_e64 v209, 1.0, v204, vcc
    v_cndmask_b32_e64 v211, 0, 1.0, vcc
    s_waitcnt lgkmcnt(0)
    s_mov_b32 s4, s48
    s_and_b32 s5, s49, 0xffff
    s_mov_b32 s6, 13107200
    s_mov_b32 s7, 0x00020000
    s_mov_b32 s12, s50
    s_and_b32 s13, s51, 0xffff
    s_mov_b32 s14, 512
    s_mov_b32 s15, 0x00020000
    s_mov_b32 s16, s52
    s_and_b32 s17, s53, 0xffff
    s_mov_b32 s18, 512
    s_mov_b32 s19, 0x00020000
    s_mov_b32 s20, s54
    s_and_b32 s21, s55, 0xffff
    s_mov_b32 s22, 512
    s_mov_b32 s23, 0x00020000
    s_mov_b32 s24, s56
    s_and_b32 s25, s57, 0xffff
    s_mov_b32 s26, 512
    s_mov_b32 s27, 0x00020000
    s_mov_b32 s8, s58
    s_and_b32 s9, s59, 0xffff
    s_mov_b32 s10, 13107200
    s_mov_b32 s11, 0x00020000
    v_lshlrev_b32 v212, 4, v1
    s_lshl_b32 s31, s29, 11
    s_mov_b64 exec, 0xffffffff
    buffer_load_dwordx4 v[172:175], v212, s[12:15], 0 offen
    buffer_load_dwordx4 v[176:179], v212, s[16:19], 0 offen
    buffer_load_dwordx4 v[180:183], v212, s[20:23], 0 offen
    buffer_load_dwordx4 v[184:187], v212, s[24:27], 0 offen
    s_mov_b64 exec, -1
    v_add_u32 v212, s31, v212
    s_add_u32 s30, s28, 0
    buffer_load_dwordx4 v[220:223], v3, s[4:7], s30 offen offset:0
    buffer_load_dwordx4 v[224:227], v3, s[4:7], s30 offen offset:1024
    buffer_load_dwordx4 v[228:231], v3, s[4:7], s30 offen offset:2048
    buffer_load_dwordx4 v[232:235], v4, s[4:7], s30 offen offset:3072
    s_waitcnt vmcnt(4)
    s_mov_b64 exec, 0xffffffff
    ds_write_b128 v212, v[172:175] offset:0
    ds_write_b128 v212, v[176:179] offset:512
    ds_write_b128 v212, v[180:183] offset:1024
    ds_write_b128 v212, v[184:187] offset:1536
    s_mov_b64 exec, -1
    v_cmp_gt_u32 vcc, 16, v1
    v_mov_b32 v213, 512
    s_nop 0
    v_cndmask_b32_e64 v213, 0, v213, vcc
    v_add3_u32 v213, v213, v206, s31
    v_add_u32 v214, 1536, v207
    v_cndmask_b32_e64 v214, v214, v206, vcc
    v_add_u32 v214, s31, v214
    v_mov_b32 v215, 32
    v_cndmask_b32_e64 v215, v215, 16, vcc
    v_add_u32 v216, 1024, v210
    v_add_u32 v216, s31, v216
    s_waitcnt lgkmcnt(0)
    ds_read_u16 v140, v213 offset:0
    v_mad_u32_u24 v217, v215, 0, v214
    ds_read_u16 v148, v217
    ds_read_u16 v156, v216 offset:0
    ds_read_u16 v141, v213 offset:16
    v_mad_u32_u24 v217, v215, 1, v214
    ds_read_u16 v149, v217
    ds_read_u16 v157, v216 offset:16
    ds_read_u16 v142, v213 offset:32
    v_mad_u32_u24 v217, v215, 2, v214
    ds_read_u16 v150, v217
    ds_read_u16 v158, v216 offset:32
    ds_read_u16 v143, v213 offset:48
    v_mad_u32_u24 v217, v215, 3, v214
    ds_read_u16 v151, v217
    ds_read_u16 v159, v216 offset:48
    ds_read_u16 v144, v213 offset:64
    v_mad_u32_u24 v217, v215, 4, v214
    ds_read_u16 v152, v217
    ds_read_u16 v160, v216 offset:64
    ds_read_u16 v145, v213 offset:80
    v_mad_u32_u24 v217, v215, 5, v214
    ds_read_u16 v153, v217
    ds_read_u16 v161, v216 offset:80
    ds_read_u16 v146, v213 offset:96
    v_mad_u32_u24 v217, v215, 6, v214
    ds_read_u16 v154, v217
    ds_read_u16 v162, v216 offset:96
    ds_read_u16 v147, v213 offset:112
    v_mad_u32_u24 v217, v215, 7, v214
    ds_read_u16 v155, v217
    ds_read_u16 v163, v216 offset:112
    s_waitcnt lgkmcnt(0)
    v_lshlrev_b32 v140, 16, v140
    v_lshlrev_b32 v148, 16, v148
    v_lshlrev_b32 v156, 16, v156
    v_mul_f32 v140, v208, v140
    v_mul_f32 v148, v209, v148
    v_mul_f32 v156, v211, v156
    v_lshlrev_b32 v141, 16, v141
    v_lshlrev_b32 v149, 16, v149
    v_lshlrev_b32 v157, 16, v157
    v_mul_f32 v141, v208, v141
    v_mul_f32 v149, v209, v149
    v_mul_f32 v157, v211, v157
    v_lshlrev_b32 v142, 16, v142
    v_lshlrev_b32 v150, 16, v150
    v_lshlrev_b32 v158, 16, v158
    v_mul_f32 v142, v208, v142
    v_mul_f32 v150, v209, v150
    v_mul_f32 v158, v211, v158
    v_lshlrev_b32 v143, 16, v143
    v_lshlrev_b32 v151, 16, v151
    v_lshlrev_b32 v159, 16, v159
    v_mul_f32 v143, v208, v143
    v_mul_f32 v151, v209, v151
    v_mul_f32 v159, v211, v159
    v_lshlrev_b32 v144, 16, v144
    v_lshlrev_b32 v152, 16, v152
    v_lshlrev_b32 v160, 16, v160
    v_mul_f32 v144, v208, v144
    v_mul_f32 v152, v209, v152
    v_mul_f32 v160, v211, v160
    v_lshlrev_b32 v145, 16, v145
    v_lshlrev_b32 v153, 16, v153
    v_lshlrev_b32 v161, 16, v161
    v_mul_f32 v145, v208, v145
    v_mul_f32 v153, v209, v153
    v_mul_f32 v161, v211, v161
    v_lshlrev_b32 v146, 16, v146
    v_lshlrev_b32 v154, 16, v154
    v_lshlrev_b32 v162, 16, v162
    v_mul_f32 v146, v208, v146
    v_mul_f32 v154, v209, v154
    v_mul_f32 v162, v211, v162
    v_lshlrev_b32 v147, 16, v147
    v_lshlrev_b32 v155, 16, v155
    v_lshlrev_b32 v163, 16, v163
    v_mul_f32 v147, v208, v147
    v_mul_f32 v155, v209, v155
    v_mul_f32 v163, v211, v163
    v_cvt_pk_bf16_f32 v236, v140, v141
    v_cvt_pk_bf16_f32 v12, v148, v149
    v_cvt_pk_bf16_f32 v240, v156, v157
    v_cvt_pk_bf16_f32 v237, v142, v143
    v_cvt_pk_bf16_f32 v13, v150, v151
    v_cvt_pk_bf16_f32 v241, v158, v159
    v_cvt_pk_bf16_f32 v238, v144, v145
    v_cvt_pk_bf16_f32 v14, v152, v153
    v_cvt_pk_bf16_f32 v242, v160, v161
    v_cvt_pk_bf16_f32 v239, v146, v147
    v_cvt_pk_bf16_f32 v15, v154, v155
    v_cvt_pk_bf16_f32 v243, v162, v163
    s_add_u32 s46, s28, 0
    buffer_load_dwordx4 v[188:191], v3, s[4:7], s46 offen
    s_waitcnt vmcnt(4)
    v_mfma_f32_32x32x16_bf16 v[140:155], v[236:239], v[220:223], 0
    v_mfma_f32_32x32x16_bf16 v[156:171], v[220:223], v[240:243], 0
    s_waitcnt vmcnt(3)
    v_mfma_f32_32x32x16_bf16 v[172:187], v[236:239], v[224:227], 0
    v_mfma_f32_32x32x16_bf16 v[108:123], v[224:227], v[240:243], 0
    s_nop 7
    v_cvt_pk_bf16_f32 v20, v140, v141
    v_cvt_pk_bf16_f32 v21, v142, v143
    v_cvt_pk_bf16_f32 v22, v144, v145
    v_cvt_pk_bf16_f32 v23, v146, v147
    v_mul_f32 v246, v140, v140
    v_mul_f32 v247, v148, v148
    v_fmac_f32 v246, v141, v141
    v_fmac_f32 v247, v149, v149
    v_fmac_f32 v246, v142, v142
    v_fmac_f32 v247, v150, v150
    v_fmac_f32 v246, v143, v143
    v_fmac_f32 v247, v151, v151
    v_fmac_f32 v246, v144, v144
    v_fmac_f32 v247, v152, v152
    v_fmac_f32 v246, v145, v145
    v_fmac_f32 v247, v153, v153
    v_fmac_f32 v246, v146, v146
    v_fmac_f32 v247, v154, v154
    v_fmac_f32 v246, v147, v147
    v_fmac_f32 v247, v155, v155
    v_mov_b32 v244, v246
    v_mov_b32 v245, v247
    v_cvt_pk_bf16_f32 v52, v156, v157
    v_cvt_pk_bf16_f32 v53, v158, v159
    v_cvt_pk_bf16_f32 v54, v160, v161
    v_cvt_pk_bf16_f32 v55, v162, v163
    v_cvt_pk_bf16_f32 v56, v164, v165
    v_cvt_pk_bf16_f32 v57, v166, v167
    v_cvt_pk_bf16_f32 v58, v168, v169
    v_cvt_pk_bf16_f32 v59, v170, v171
    v_or_b32 v52, v52, v6
    v_or_b32 v53, v53, v6
    v_or_b32 v54, v54, v6
    v_or_b32 v55, v55, v6
    v_or_b32 v56, v56, v6
    v_or_b32 v57, v57, v6
    v_or_b32 v58, v58, v6
    v_or_b32 v59, v59, v6
    s_waitcnt vmcnt(2)
    v_mfma_f32_32x32x16_bf16 v[140:155], v[236:239], v[228:231], 0
    v_mfma_f32_32x32x16_bf16 v[156:171], v[228:231], v[240:243], 0
    v_cvt_pk_bf16_f32 v24, v172, v173
    v_cvt_pk_bf16_f32 v25, v174, v175
    v_cvt_pk_bf16_f32 v26, v176, v177
    v_cvt_pk_bf16_f32 v27, v178, v179
    v_mul_f32 v246, v172, v172
    v_mul_f32 v247, v180, v180
    v_fmac_f32 v246, v173, v173
    v_fmac_f32 v247, v181, v181
    v_fmac_f32 v246, v174, v174
    v_fmac_f32 v247, v182, v182
    v_fmac_f32 v246, v175, v175
    v_fmac_f32 v247, v183, v183
    v_fmac_f32 v246, v176, v176
    v_fmac_f32 v247, v184, v184
    v_fmac_f32 v246, v177, v177
    v_fmac_f32 v247, v185, v185
    v_fmac_f32 v246, v178, v178
    v_fmac_f32 v247, v186, v186
    v_fmac_f32 v246, v179, v179
    v_fmac_f32 v247, v187, v187
    v_max_f32 v244, v244, v246
    v_max_f32 v245, v245, v247
    v_cvt_pk_bf16_f32 v60, v108, v109
    v_cvt_pk_bf16_f32 v61, v110, v111
    v_cvt_pk_bf16_f32 v62, v112, v113
    v_cvt_pk_bf16_f32 v63, v114, v115
    v_cvt_pk_bf16_f32 v64, v116, v117
    v_cvt_pk_bf16_f32 v65, v118, v119
    v_cvt_pk_bf16_f32 v66, v120, v121
    v_cvt_pk_bf16_f32 v67, v122, v123
    v_or_b32 v60, v60, v6
    v_or_b32 v61, v61, v6
    v_or_b32 v62, v62, v6
    v_or_b32 v63, v63, v6
    v_or_b32 v64, v64, v6
    v_or_b32 v65, v65, v6
    v_or_b32 v66, v66, v6
    v_or_b32 v67, v67, v6
    s_waitcnt vmcnt(1)
    v_mfma_f32_32x32x16_bf16 v[172:187], v[236:239], v[232:235], 0
    v_mfma_f32_32x32x16_bf16 v[108:123], v[232:235], v[240:243], 0
    v_cvt_pk_bf16_f32 v28, v140, v141
    v_cvt_pk_bf16_f32 v29, v142, v143
    v_cvt_pk_bf16_f32 v30, v144, v145
    v_cvt_pk_bf16_f32 v31, v146, v147
    v_mul_f32 v246, v140, v140
    v_mul_f32 v247, v148, v148
    v_fmac_f32 v246, v141, v141
    v_fmac_f32 v247, v149, v149
    v_fmac_f32 v246, v142, v142
    v_fmac_f32 v247, v150, v150
    v_fmac_f32 v246, v143, v143
    v_fmac_f32 v247, v151, v151
    v_fmac_f32 v246, v144, v144
    v_fmac_f32 v247, v152, v152
    v_fmac_f32 v246, v145, v145
    v_fmac_f32 v247, v153, v153
    v_fmac_f32 v246, v146, v146
    v_fmac_f32 v247, v154, v154
    v_fmac_f32 v246, v147, v147
    v_fmac_f32 v247, v155, v155
    v_max_f32 v244, v244, v246
    v_max_f32 v245, v245, v247
    v_cvt_pk_bf16_f32 v68, v156, v157
    v_cvt_pk_bf16_f32 v69, v158, v159
    v_cvt_pk_bf16_f32 v70, v160, v161
    v_cvt_pk_bf16_f32 v71, v162, v163
    v_cvt_pk_bf16_f32 v72, v164, v165
    v_cvt_pk_bf16_f32 v73, v166, v167
    v_cvt_pk_bf16_f32 v74, v168, v169
    v_cvt_pk_bf16_f32 v75, v170, v171
    v_or_b32 v68, v68, v6
    v_or_b32 v69, v69, v6
    v_or_b32 v70, v70, v6
    v_or_b32 v71, v71, v6
    v_or_b32 v72, v72, v6
    v_or_b32 v73, v73, v6
    v_or_b32 v74, v74, v6
    v_or_b32 v75, v75, v6
    v_cvt_pk_bf16_f32 v32, v172, v173
    v_cvt_pk_bf16_f32 v33, v174, v175
    v_cvt_pk_bf16_f32 v34, v176, v177
    v_cvt_pk_bf16_f32 v35, v178, v179
    v_mul_f32 v246, v172, v172
    v_mul_f32 v247, v180, v180
    v_fmac_f32 v246, v173, v173
    v_fmac_f32 v247, v181, v181
    v_fmac_f32 v246, v174, v174
    v_fmac_f32 v247, v182, v182
    v_fmac_f32 v246, v175, v175
    v_fmac_f32 v247, v183, v183
    v_fmac_f32 v246, v176, v176
    v_fmac_f32 v247, v184, v184
    v_fmac_f32 v246, v177, v177
    v_fmac_f32 v247, v185, v185
    v_fmac_f32 v246, v178, v178
    v_fmac_f32 v247, v186, v186
    v_fmac_f32 v246, v179, v179
    v_fmac_f32 v247, v187, v187
    v_max_f32 v244, v244, v246
    v_max_f32 v245, v245, v247
    v_cvt_pk_bf16_f32 v76, v108, v109
    v_cvt_pk_bf16_f32 v77, v110, v111
    v_or_b32 v76, v76, v6
    v_and_b32 v76, v76, v7
    v_or_b32 v77, v77, v6
    v_and_b32 v77, v77, v7
    v_mov_b32 v78, 0
    v_mov_b32 v79, 0
    v_max_f32_dpp v244, v244, v244 row_ror:8 row_mask:0xf bank_mask:0xf
    s_nop 1
    v_max_f32_dpp v244, v244, v244 row_ror:4 row_mask:0xf bank_mask:0xf
    s_nop 1
    v_max_f32_dpp v244, v244, v244 row_ror:2 row_mask:0xf bank_mask:0xf
    s_nop 1
    v_max_f32_dpp v244, v244, v244 row_ror:1 row_mask:0xf bank_mask:0xf
    v_mov_b32 v213, v244
    s_nop 1
    v_permlane16_swap_b32 v244, v213
    v_max_f32 v244, v244, v213
    v_max_f32_dpp v245, v245, v245 row_ror:8 row_mask:0xf bank_mask:0xf
    s_nop 1
    v_max_f32_dpp v245, v245, v245 row_ror:4 row_mask:0xf bank_mask:0xf
    s_nop 1
    v_max_f32_dpp v245, v245, v245 row_ror:2 row_mask:0xf bank_mask:0xf
    s_nop 1
    v_max_f32_dpp v245, v245, v245 row_ror:1 row_mask:0xf bank_mask:0xf
    v_mov_b32 v213, v245
    s_nop 1
    v_permlane16_swap_b32 v245, v213
    v_max_f32 v245, v245, v213
    v_mul_f32 v244, v244, v245
    v_sqrt_f32 v244, v244
    v_mov_b32 v213, 0xbf820000
    v_mul_f32 v244, v213, v244
    v_mov_b32 v17, v244
    v_mov_b32 v16, v244
    s_nop 1
    v_permlane32_swap_b32 v16, v17
    s_add_u32 s30, s28, 3200
    buffer_load_dwordx4 v[220:223], v3, s[4:7], s30 offen offset:0
    buffer_load_dwordx4 v[224:227], v3, s[4:7], s30 offen offset:1024
    buffer_load_dwordx4 v[228:231], v3, s[4:7], s30 offen offset:2048
    buffer_load_dwordx4 v[232:235], v4, s[4:7], s30 offen offset:3072
    s_waitcnt vmcnt(4)
    v_mfma_f32_32x32x16_bf16 v[172:187], v[12:15], v[188:191], 0
    s_add_u32 s46, s28, 1024
    buffer_load_dwordx4 v[188:191], v3, s[4:7], s46 offen
    v_mov_b32 v140, v16
    v_mov_b32 v141, v16
    v_mov_b32 v142, v16
    v_mov_b32 v143, v16
    v_mov_b32 v144, v16
    v_mov_b32 v145, v16
    v_mov_b32 v146, v16
    v_mov_b32 v147, v16
    v_mov_b32 v148, v16
    v_mov_b32 v149, v16
    v_mov_b32 v150, v16
    v_mov_b32 v151, v16
    v_mov_b32 v152, v16
    v_mov_b32 v153, v16
    v_mov_b32 v154, v16
    v_mov_b32 v155, v16
    v_cvt_pk_bf16_f32 v192, v172, v173
    v_cvt_pk_bf16_f32 v193, v174, v175
    v_cvt_pk_bf16_f32 v194, v176, v177
    v_cvt_pk_bf16_f32 v195, v178, v179
    v_and_b32 v192, v192, v7
    v_and_b32 v193, v193, v7
    v_and_b32 v194, v194, v7
    v_and_b32 v195, v195, v7
    v_mov_b32 v208, v180
    v_mov_b32 v209, v181
    v_mov_b32 v210, v182
    v_mov_b32 v211, v183
    v_mfma_f32_32x32x16_bf16 v[108:123], v[20:23], v[192:195], v[140:155]
    v_mfma_f32_32x32x16_bf16 v[124:139], v[24:27], v[192:195], v[140:155]
L_p2_0:
    s_nop 10
    v_exp_f32 v108, v108
    v_exp_f32 v109, v109
    v_exp_f32 v110, v110
    v_exp_f32 v111, v111
    v_exp_f32 v112, v112
    v_exp_f32 v113, v113
    v_exp_f32 v114, v114
    v_exp_f32 v115, v115
    v_cvt_pk_bf16_f32 v196, v108, v109
    v_cvt_pk_bf16_f32 v197, v110, v111
    v_cvt_pk_bf16_f32 v198, v112, v113
    v_cvt_pk_bf16_f32 v199, v114, v115
    v_exp_f32 v116, v116
    s_nop 0
    v_mfma_f32_32x32x16_bf16 v[156:171], v[52:55], v[196:199], 0
    v_exp_f32 v117, v117
    v_exp_f32 v118, v118
    v_exp_f32 v119, v119
    v_exp_f32 v120, v120
    v_exp_f32 v121, v121
    v_exp_f32 v122, v122
    v_exp_f32 v123, v123
    v_cvt_pk_bf16_f32 v200, v116, v117
    v_cvt_pk_bf16_f32 v201, v118, v119
    v_cvt_pk_bf16_f32 v202, v120, v121
    v_cvt_pk_bf16_f32 v203, v122, v123
    v_exp_f32 v124, v124
    s_nop 0
    v_mfma_f32_32x32x16_bf16 v[156:171], v[56:59], v[200:203], v[156:171]
    v_exp_f32 v125, v125
    v_mfma_f32_32x32x16_bf16 v[108:123], v[28:31], v[192:195], v[140:155]
    v_exp_f32 v126, v126
    s_waitcnt vmcnt(0)
    v_exp_f32 v127, v127
    v_mfma_f32_32x32x16_bf16 v[172:187], v[12:15], v[188:191], 0
    v_exp_f32 v128, v128
    s_add_u32 s46, s28, 2048
    v_exp_f32 v129, v129
    buffer_load_dwordx4 v[188:191], v3, s[4:7], s46 offen
    v_exp_f32 v130, v130
    v_exp_f32 v131, v131
    v_cvt_pk_bf16_f32 v196, v124, v125
    v_cvt_pk_bf16_f32 v197, v126, v127
    v_cvt_pk_bf16_f32 v198, v128, v129
    v_cvt_pk_bf16_f32 v199, v130, v131
    v_exp_f32 v132, v132
    s_nop 0
    v_mfma_f32_32x32x16_bf16 v[156:171], v[60:63], v[196:199], v[156:171]
    v_exp_f32 v133, v133
    v_exp_f32 v134, v134
    v_exp_f32 v135, v135
    v_exp_f32 v136, v136
    v_exp_f32 v137, v137
    v_exp_f32 v138, v138
    v_exp_f32 v139, v139
    v_cvt_pk_bf16_f32 v200, v132, v133
    v_cvt_pk_bf16_f32 v201, v134, v135
    v_cvt_pk_bf16_f32 v202, v136, v137
    v_cvt_pk_bf16_f32 v203, v138, v139
    v_exp_f32 v108, v108
    s_nop 0
    v_mfma_f32_32x32x16_bf16 v[156:171], v[64:67], v[200:203], v[156:171]
    v_exp_f32 v109, v109
    v_mfma_f32_32x32x16_bf16 v[124:139], v[32:35], v[192:195], v[140:155]
    v_exp_f32 v110, v110
    v_cvt_pk_bf16_f32 v204, v172, v173
    v_exp_f32 v111, v111
    v_cvt_pk_bf16_f32 v205, v174, v175
    v_exp_f32 v112, v112
    v_cvt_pk_bf16_f32 v206, v176, v177
    v_exp_f32 v113, v113
    v_cvt_pk_bf16_f32 v207, v178, v179
    v_exp_f32 v114, v114
    v_and_b32 v204, v204, v7
    v_exp_f32 v115, v115
    v_and_b32 v205, v205, v7
    v_cvt_pk_bf16_f32 v196, v108, v109
    v_cvt_pk_bf16_f32 v197, v110, v111
    v_cvt_pk_bf16_f32 v198, v112, v113
    v_cvt_pk_bf16_f32 v199, v114, v115
    v_exp_f32 v116, v116
    s_nop 0
    v_mfma_f32_32x32x16_bf16 v[156:171], v[68:71], v[196:199], v[156:171]
    v_exp_f32 v117, v117
    v_and_b32 v206, v206, v7
    v_exp_f32 v118, v118
    v_and_b32 v207, v207, v7
    v_exp_f32 v119, v119
    v_mov_b32 v244, v180
    v_exp_f32 v120, v120
    v_mov_b32 v245, v181
    v_exp_f32 v121, v121
    v_mov_b32 v246, v182
    v_exp_f32 v122, v122
    v_mov_b32 v247, v183
    v_exp_f32 v123, v123
    v_cvt_pk_bf16_f32 v200, v116, v117
    v_cvt_pk_bf16_f32 v201, v118, v119
    v_cvt_pk_bf16_f32 v202, v120, v121
    v_cvt_pk_bf16_f32 v203, v122, v123
    v_exp_f32 v124, v124
    s_nop 0
    v_mfma_f32_32x32x16_bf16 v[156:171], v[72:75], v[200:203], v[156:171]
    v_exp_f32 v125, v125
    v_exp_f32 v126, v126
    v_exp_f32 v127, v127
    v_cvt_pk_bf16_f32 v196, v124, v125
    v_cvt_pk_bf16_f32 v197, v126, v127
    v_mov_b32 v198, 0
    v_mov_b32 v199, 0
    s_nop 1
    v_mfma_f32_32x32x16_bf16 v[156:171], v[76:79], v[196:199], v[156:171]
    v_mfma_f32_32x32x16_bf16 v[108:123], v[20:23], v[204:207], v[140:155]
    v_mfma_f32_32x32x16_bf16 v[124:139], v[24:27], v[204:207], v[140:155]
    v_mov_b32 v216, 0x21800000
    s_nop 8
    v_cmp_nle_f32 vcc, v216, v164
    s_cbranch_vccnz L_fb_0
    v_rcp_f32 v216, v164
    s_add_u32 s47, s28, 0
    v_fma_f32 v212, v156, v216, v208
    v_fma_f32 v213, v157, v216, v209
    v_fma_f32 v214, v158, v216, v210
    v_fma_f32 v215, v159, v216, v211
    v_cvt_pk_bf16_f32 v212, v212, v213
    v_cvt_pk_bf16_f32 v213, v214, v215
    v_pk_max_i16 v212, v212, 0
    v_pk_max_i16 v213, v213, 0
    buffer_store_dwordx2 v[212:213], v5, s[8:11], s47 offen offset:0
L_after_0:
L_p2_1:
    v_exp_f32 v108, v108
    v_exp_f32 v109, v109
    v_exp_f32 v110, v110
    v_exp_f32 v111, v111
    v_exp_f32 v112, v112
    v_exp_f32 v113, v113
    v_exp_f32 v114, v114
    v_exp_f32 v115, v115
    v_cvt_pk_bf16_f32 v196, v108, v109
    v_cvt_pk_bf16_f32 v197, v110, v111
    v_cvt_pk_bf16_f32 v198, v112, v113
    v_cvt_pk_bf16_f32 v199, v114, v115
    v_exp_f32 v116, v116
    s_nop 0
    v_mfma_f32_32x32x16_bf16 v[156:171], v[52:55], v[196:199], 0
    v_exp_f32 v117, v117
    v_exp_f32 v118, v118
    v_exp_f32 v119, v119
    v_exp_f32 v120, v120
    v_exp_f32 v121, v121
    v_exp_f32 v122, v122
    v_exp_f32 v123, v123
    v_cvt_pk_bf16_f32 v200, v116, v117
    v_cvt_pk_bf16_f32 v201, v118, v119
    v_cvt_pk_bf16_f32 v202, v120, v121
    v_cvt_pk_bf16_f32 v203, v122, v123
    v_exp_f32 v124, v124
    s_nop 0
    v_mfma_f32_32x32x16_bf16 v[156:171], v[56:59], v[200:203], v[156:171]
    v_exp_f32 v125, v125
    v_mfma_f32_32x32x16_bf16 v[108:123], v[28:31], v[204:207], v[140:155]
    v_exp_f32 v126, v126
    s_waitcnt vmcnt(1)
    v_exp_f32 v127, v127
    v_mfma_f32_32x32x16_bf16 v[172:187], v[12:15], v[188:191], 0
    v_exp_f32 v128, v128
    v_cmp_le_u32 s[40:41], 4, v1
    v_exp_f32 v129, v129
    v_mov_b32 v212, 3072
    v_exp_f32 v130, v130
    v_mov_b32 v213, -128
    v_exp_f32 v131, v131
    v_cndmask_b32_e64 v212, v212, v213, s[40:41]
    v_cvt_pk_bf16_f32 v196, v124, v125
    v_cvt_pk_bf16_f32 v197, v126, v127
    v_cvt_pk_bf16_f32 v198, v128, v129
    v_cvt_pk_bf16_f32 v199, v130, v131
    v_exp_f32 v132, v132
    s_nop 0
    v_mfma_f32_32x32x16_bf16 v[156:171], v[60:63], v[196:199], v[156:171]
    v_exp_f32 v133, v133
    v_add_u32 v212, v3, v212
    v_exp_f32 v134, v134
    buffer_load_dwordx4 v[188:191], v212, s[4:7], s28 offen
    v_exp_f32 v135, v135
    v_exp_f32 v136, v136
    v_exp_f32 v137, v137
    v_exp_f32 v138, v138
    v_exp_f32 v139, v139
    v_cvt_pk_bf16_f32 v200, v132, v133
    v_cvt_pk_bf16_f32 v201, v134, v135
    v_cvt_pk_bf16_f32 v202, v136, v137
    v_cvt_pk_bf16_f32 v203, v138, v139
    v_exp_f32 v108, v108
    s_nop 0
    v_mfma_f32_32x32x16_bf16 v[156:171], v[64:67], v[200:203], v[156:171]
    v_exp_f32 v109, v109
    v_mfma_f32_32x32x16_bf16 v[124:139], v[32:35], v[204:207], v[140:155]
    v_exp_f32 v110, v110
    v_cvt_pk_bf16_f32 v192, v172, v173
    v_exp_f32 v111, v111
    v_cvt_pk_bf16_f32 v193, v174, v175
    v_exp_f32 v112, v112
    v_cvt_pk_bf16_f32 v194, v176, v177
    v_exp_f32 v113, v113
    v_cvt_pk_bf16_f32 v195, v178, v179
    v_exp_f32 v114, v114
    v_and_b32 v192, v192, v7
    v_exp_f32 v115, v115
    v_and_b32 v193, v193, v7
    v_cvt_pk_bf16_f32 v196, v108, v109
    v_cvt_pk_bf16_f32 v197, v110, v111
    v_cvt_pk_bf16_f32 v198, v112, v113
    v_cvt_pk_bf16_f32 v199, v114, v115
    v_exp_f32 v116, v116
    s_nop 0
    v_mfma_f32_32x32x16_bf16 v[156:171], v[68:71], v[196:199], v[156:171]
    v_exp_f32 v117, v117
    v_and_b32 v194, v194, v7
    v_exp_f32 v118, v118
    v_and_b32 v195, v195, v7
    v_exp_f32 v119, v119
    v_mov_b32 v208, v180
    v_exp_f32 v120, v120
    v_mov_b32 v209, v181
    v_exp_f32 v121, v121
    v_mov_b32 v210, v182
    v_exp_f32 v122, v122
    v_mov_b32 v211, v183
    v_exp_f32 v123, v123
    v_cvt_pk_bf16_f32 v200, v116, v117
    v_cvt_pk_bf16_f32 v201, v118, v119
    v_cvt_pk_bf16_f32 v202, v120, v121
    v_cvt_pk_bf16_f32 v203, v122, v123
    v_exp_f32 v124, v124
    s_nop 0
    v_mfma_f32_32x32x16_bf16 v[156:171], v[72:75], v[200:203], v[156:171]
    v_exp_f32 v125, v125
    v_exp_f32 v126, v126
    v_exp_f32 v127, v127
    v_cvt_pk_bf16_f32 v196, v124, v125
    v_cvt_pk_bf16_f32 v197, v126, v127
    v_mov_b32 v198, 0
    v_mov_b32 v199, 0
    s_nop 1
    v_mfma_f32_32x32x16_bf16 v[156:171], v[76:79], v[196:199], v[156:171]
    v_mfma_f32_32x32x16_bf16 v[108:123], v[20:23], v[192:195], v[140:155]
    v_mfma_f32_32x32x16_bf16 v[124:139], v[24:27], v[192:195], v[140:155]
    v_mov_b32 v216, 0x21800000
    s_nop 8
    v_cmp_nle_f32 vcc, v216, v164
    s_cbranch_vccnz L_fb_1
    v_rcp_f32 v216, v164
    s_add_u32 s47, s28, 1024
    v_fma_f32 v212, v156, v216, v244
    v_fma_f32 v213, v157, v216, v245
    v_fma_f32 v214, v158, v216, v246
    v_fma_f32 v215, v159, v216, v247
    v_cvt_pk_bf16_f32 v212, v212, v213
    v_cvt_pk_bf16_f32 v213, v214, v215
    v_pk_max_i16 v212, v212, 0
    v_pk_max_i16 v213, v213, 0
    buffer_store_dwordx2 v[212:213], v5, s[8:11], s47 offen offset:0
L_after_1:
L_p2_2:
    v_exp_f32 v108, v108
    v_exp_f32 v109, v109
    v_exp_f32 v110, v110
    v_exp_f32 v111, v111
    v_exp_f32 v112, v112
    v_exp_f32 v113, v113
    v_exp_f32 v114, v114
    v_exp_f32 v115, v115
    v_cvt_pk_bf16_f32 v196, v108, v109
    v_cvt_pk_bf16_f32 v197, v110, v111
    v_cvt_pk_bf16_f32 v198, v112, v113
    v_cvt_pk_bf16_f32 v199, v114, v115
    v_exp_f32 v116, v116
    s_nop 0
    v_mfma_f32_32x32x16_bf16 v[156:171], v[52:55], v[196:199], 0
    v_exp_f32 v117, v117
    v_exp_f32 v118, v118
    v_exp_f32 v119, v119
    v_exp_f32 v120, v120
    v_exp_f32 v121, v121
    v_exp_f32 v122, v122
    v_exp_f32 v123, v123
    v_cvt_pk_bf16_f32 v200, v116, v117
    v_cvt_pk_bf16_f32 v201, v118, v119
    v_cvt_pk_bf16_f32 v202, v120, v121
    v_cvt_pk_bf16_f32 v203, v122, v123
    v_exp_f32 v124, v124
    s_nop 0
    v_mfma_f32_32x32x16_bf16 v[156:171], v[56:59], v[200:203], v[156:171]
    v_exp_f32 v125, v125
    v_mfma_f32_32x32x16_bf16 v[108:123], v[28:31], v[192:195], v[140:155]
    v_exp_f32 v126, v126
    s_waitcnt vmcnt(1)
    v_exp_f32 v127, v127
    v_mfma_f32_32x32x16_bf16 v[172:187], v[12:15], v[188:191], 0
    v_exp_f32 v128, v128
    s_add_u32 s46, s28, 896
    v_exp_f32 v129, v129
    buffer_load_dwordx4 v[188:191], v3, s[4:7], s46 offen
    v_exp_f32 v130, v130
    v_exp_f32 v131, v131
    v_cvt_pk_bf16_f32 v196, v124, v125
    v_cvt_pk_bf16_f32 v197, v126, v127
    v_cvt_pk_bf16_f32 v198, v128, v129
    v_cvt_pk_bf16_f32 v199, v130, v131
    v_exp_f32 v132, v132
    s_nop 0
    v_mfma_f32_32x32x16_bf16 v[156:171], v[60:63], v[196:199], v[156:171]
    v_exp_f32 v133, v133
    v_exp_f32 v134, v134
    v_exp_f32 v135, v135
    v_exp_f32 v136, v136
    v_exp_f32 v137, v137
    v_exp_f32 v138, v138
    v_exp_f32 v139, v139
    v_cvt_pk_bf16_f32 v200, v132, v133
    v_cvt_pk_bf16_f32 v201, v134, v135
    v_cvt_pk_bf16_f32 v202, v136, v137
    v_cvt_pk_bf16_f32 v203, v138, v139
    v_exp_f32 v108, v108
    s_nop 0
    v_mfma_f32_32x32x16_bf16 v[156:171], v[64:67], v[200:203], v[156:171]
    v_exp_f32 v109, v109
    v_mfma_f32_32x32x16_bf16 v[124:139], v[32:35], v[192:195], v[140:155]
    v_exp_f32 v110, v110
    v_cmp_le_u32 s[38:39], 4, v1
    v_exp_f32 v111, v111
    v_cvt_pk_bf16_f32 v204, v172, v173
    v_exp_f32 v112, v112
    v_cvt_pk_bf16_f32 v205, v174, v175
    v_exp_f32 v113, v113
    v_cvt_pk_bf16_f32 v206, v176, v177
    v_exp_f32 v114, v114
    v_cvt_pk_bf16_f32 v207, v178, v179
    v_exp_f32 v115, v115
    v_cndmask_b32_e64 v217, v7, v8, s[38:39]
    v_cvt_pk_bf16_f32 v196, v108, v109
    v_cvt_pk_bf16_f32 v197, v110, v111
    v_cvt_pk_bf16_f32 v198, v112, v113
    v_cvt_pk_bf16_f32 v199, v114, v115
    v_exp_f32 v116, v116
    s_nop 0
    v_mfma_f32_32x32x16_bf16 v[156:171], v[68:71], v[196:199], v[156:171]
    v_exp_f32 v117, v117
    v_and_b32 v204, v204, v217
    v_exp_f32 v118, v118
    v_and_b32 v205, v205, v217
    v_exp_f32 v119, v119
    v_and_b32 v206, v206, v217
    v_exp_f32 v120, v120
    v_and_b32 v207, v207, v217
    v_exp_f32 v121, v121
    v_cndmask_b32_e64 v244, v180, v184, s[38:39]
    v_exp_f32 v122, v122
    v_cndmask_b32_e64 v245, v181, v185, s[38:39]
    v_exp_f32 v123, v123
    v_cndmask_b32_e64 v246, v182, v186, s[38:39]
    v_cvt_pk_bf16_f32 v200, v116, v117
    v_cvt_pk_bf16_f32 v201, v118, v119
    v_cvt_pk_bf16_f32 v202, v120, v121
    v_cvt_pk_bf16_f32 v203, v122, v123
    v_exp_f32 v124, v124
    s_nop 0
    v_mfma_f32_32x32x16_bf16 v[156:171], v[72:75], v[200:203], v[156:171]
    v_exp_f32 v125, v125
    v_cndmask_b32_e64 v247, v183, v187, s[38:39]
    v_exp_f32 v126, v126
    v_cndmask_b32_e64 v216, v16, v17, s[38:39]
    v_exp_f32 v127, v127
    v_mov_b32 v140, v216
    v_cvt_pk_bf16_f32 v196, v124, v125
    v_cvt_pk_bf16_f32 v197, v126, v127
    v_mov_b32 v198, 0
    v_mov_b32 v199, 0
    s_nop 1
    v_mfma_f32_32x32x16_bf16 v[156:171], v[76:79], v[196:199], v[156:171]
    v_mov_b32 v141, v216
    v_mov_b32 v142, v216
    v_mov_b32 v143, v216
    v_mov_b32 v144, v216
    v_mov_b32 v145, v216
    v_mov_b32 v146, v216
    v_mov_b32 v147, v216
    v_mov_b32 v148, v216
    v_mov_b32 v149, v216
    v_mov_b32 v150, v216
    v_mov_b32 v151, v216
    v_mov_b32 v152, v216
    v_mov_b32 v153, v216
    v_mov_b32 v154, v216
    v_mov_b32 v155, v216
    s_nop 1
    v_mfma_f32_32x32x16_bf16 v[108:123], v[20:23], v[204:207], v[140:155]
    v_mfma_f32_32x32x16_bf16 v[124:139], v[24:27], v[204:207], v[140:155]
    v_mov_b32 v216, 0x21800000
    v_cmp_nle_f32 vcc, v216, v164
    s_cbranch_vccnz L_fb_2
    v_rcp_f32 v216, v164
    s_add_u32 s47, s28, 2048
    v_fma_f32 v212, v156, v216, v208
    v_fma_f32 v213, v157, v216, v209
    v_fma_f32 v214, v158, v216, v210
    v_fma_f32 v215, v159, v216, v211
    v_cvt_pk_bf16_f32 v212, v212, v213
    v_cvt_pk_bf16_f32 v213, v214, v215
    v_pk_max_i16 v212, v212, 0
    v_pk_max_i16 v213, v213, 0
    buffer_store_dwordx2 v[212:213], v5, s[8:11], s47 offen offset:0
L_after_2:
L_p2_3:
    v_exp_f32 v108, v108
    v_exp_f32 v109, v109
    v_exp_f32 v110, v110
    v_exp_f32 v111, v111
    v_exp_f32 v112, v112
    v_exp_f32 v113, v113
    v_exp_f32 v114, v114
    v_exp_f32 v115, v115
    v_cvt_pk_bf16_f32 v196, v108, v109
    v_cvt_pk_bf16_f32 v197, v110, v111
    v_cvt_pk_bf16_f32 v198, v112, v113
    v_cvt_pk_bf16_f32 v199, v114, v115
    v_exp_f32 v116, v116
    s_nop 0
    v_mfma_f32_32x32x16_bf16 v[156:171], v[52:55], v[196:199], 0
    v_exp_f32 v117, v117
    v_exp_f32 v118, v118
    v_exp_f32 v119, v119
    v_exp_f32 v120, v120
    v_exp_f32 v121, v121
    v_exp_f32 v122, v122
    v_exp_f32 v123, v123
    v_cvt_pk_bf16_f32 v200, v116, v117
    v_cvt_pk_bf16_f32 v201, v118, v119
    v_cvt_pk_bf16_f32 v202, v120, v121
    v_cvt_pk_bf16_f32 v203, v122, v123
    v_exp_f32 v124, v124
    s_nop 0
    v_mfma_f32_32x32x16_bf16 v[156:171], v[56:59], v[200:203], v[156:171]
    v_exp_f32 v125, v125
    v_mfma_f32_32x32x16_bf16 v[108:123], v[28:31], v[204:207], v[140:155]
    v_exp_f32 v126, v126
    s_waitcnt vmcnt(1)
    v_exp_f32 v127, v127
    v_mfma_f32_32x32x16_bf16 v[172:187], v[12:15], v[188:191], 0
    v_exp_f32 v128, v128
    s_add_u32 s46, s28, 1920
    v_exp_f32 v129, v129
    buffer_load_dwordx4 v[188:191], v3, s[4:7], s46 offen
    v_exp_f32 v130, v130
    v_exp_f32 v131, v131
    v_cvt_pk_bf16_f32 v196, v124, v125
    v_cvt_pk_bf16_f32 v197, v126, v127
    v_cvt_pk_bf16_f32 v198, v128, v129
    v_cvt_pk_bf16_f32 v199, v130, v131
    v_exp_f32 v132, v132
    s_nop 0
    v_mfma_f32_32x32x16_bf16 v[156:171], v[60:63], v[196:199], v[156:171]
    v_exp_f32 v133, v133
    v_exp_f32 v134, v134
    v_exp_f32 v135, v135
    v_exp_f32 v136, v136
    v_exp_f32 v137, v137
    v_exp_f32 v138, v138
    v_exp_f32 v139, v139
    v_cvt_pk_bf16_f32 v200, v132, v133
    v_cvt_pk_bf16_f32 v201, v134, v135
    v_cvt_pk_bf16_f32 v202, v136, v137
    v_cvt_pk_bf16_f32 v203, v138, v139
    v_exp_f32 v108, v108
    s_nop 0
    v_mfma_f32_32x32x16_bf16 v[156:171], v[64:67], v[200:203], v[156:171]
    v_exp_f32 v109, v109
    v_mfma_f32_32x32x16_bf16 v[124:139], v[32:35], v[204:207], v[140:155]
    v_exp_f32 v110, v110
    v_cvt_pk_bf16_f32 v192, v172, v173
    v_exp_f32 v111, v111
    v_cvt_pk_bf16_f32 v193, v174, v175
    v_exp_f32 v112, v112
    v_cvt_pk_bf16_f32 v194, v176, v177
    v_exp_f32 v113, v113
    v_cvt_pk_bf16_f32 v195, v178, v179
    v_exp_f32 v114, v114
    v_and_b32 v192, v192, v8
    v_exp_f32 v115, v115
    v_and_b32 v193, v193, v8
    v_cvt_pk_bf16_f32 v196, v108, v109
    v_cvt_pk_bf16_f32 v197, v110, v111
    v_cvt_pk_bf16_f32 v198, v112, v113
    v_cvt_pk_bf16_f32 v199, v114, v115
    v_exp_f32 v116, v116
    s_nop 0
    v_mfma_f32_32x32x16_bf16 v[156:171], v[68:71], v[196:199], v[156:171]
    v_exp_f32 v117, v117
    v_and_b32 v194, v194, v8
    v_exp_f32 v118, v118
    v_and_b32 v195, v195, v8
    v_exp_f32 v119, v119
    v_mov_b32 v208, v184
    v_exp_f32 v120, v120
    v_mov_b32 v209, v185
    v_exp_f32 v121, v121
    v_mov_b32 v210, v186
    v_exp_f32 v122, v122
    v_mov_b32 v211, v187
    v_exp_f32 v123, v123
    v_mov_b32 v140, v17
    v_cvt_pk_bf16_f32 v200, v116, v117
    v_cvt_pk_bf16_f32 v201, v118, v119
    v_cvt_pk_bf16_f32 v202, v120, v121
    v_cvt_pk_bf16_f32 v203, v122, v123
    v_exp_f32 v124, v124
    s_nop 0
    v_mfma_f32_32x32x16_bf16 v[156:171], v[72:75], v[200:203], v[156:171]
    v_exp_f32 v125, v125
    v_mov_b32 v141, v17
    v_exp_f32 v126, v126
    v_mov_b32 v142, v17
    v_exp_f32 v127, v127
    v_mov_b32 v143, v17
    v_cvt_pk_bf16_f32 v196, v124, v125
    v_cvt_pk_bf16_f32 v197, v126, v127
    v_mov_b32 v198, 0
    v_mov_b32 v199, 0
    s_nop 1
    v_mfma_f32_32x32x16_bf16 v[156:171], v[76:79], v[196:199], v[156:171]
    v_mov_b32 v144, v17
    v_mov_b32 v145, v17
    v_mov_b32 v146, v17
    v_mov_b32 v147, v17
    v_mov_b32 v148, v17
    v_mov_b32 v149, v17
    v_mov_b32 v150, v17
    v_mov_b32 v151, v17
    v_mov_b32 v152, v17
    v_mov_b32 v153, v17
    v_mov_b32 v154, v17
    v_mov_b32 v155, v17
    s_nop 1
    v_mfma_f32_32x32x16_bf16 v[108:123], v[20:23], v[192:195], v[140:155]
    v_mfma_f32_32x32x16_bf16 v[124:139], v[24:27], v[192:195], v[140:155]
    v_mov_b32 v216, 0x21800000
    v_cmp_nle_f32 vcc, v216, v164
    s_cbranch_vccnz L_fb_3
    v_rcp_f32 v216, v164
    v_cndmask_b32_e64 v212, v156, v160, s[38:39]
    v_cndmask_b32_e64 v213, v157, v161, s[38:39]
    v_cndmask_b32_e64 v214, v158, v162, s[38:39]
    v_cndmask_b32_e64 v215, v159, v163, s[38:39]
    v_mov_b32 v217, 3072
    v_mov_b32 v218, 0xffffff90
    v_cndmask_b32_e64 v217, v217, v218, s[38:39]
    v_add_u32 v217, v5, v217
    v_fma_f32 v212, v212, v216, v244
    v_fma_f32 v213, v213, v216, v245
    v_fma_f32 v214, v214, v216, v246
    v_fma_f32 v215, v215, v216, v247
    v_cvt_pk_bf16_f32 v212, v212, v213
    v_cvt_pk_bf16_f32 v213, v214, v215
    v_pk_max_i16 v212, v212, 0
    v_pk_max_i16 v213, v213, 0
    buffer_store_dwordx2 v[212:213], v217, s[8:11], s28 offen offset:0
L_after_3:
L_p2_4:
    v_exp_f32 v108, v108
    v_exp_f32 v109, v109
    v_exp_f32 v110, v110
    v_exp_f32 v111, v111
    v_exp_f32 v112, v112
    v_exp_f32 v113, v113
    v_exp_f32 v114, v114
    v_exp_f32 v115, v115
    v_cvt_pk_bf16_f32 v196, v108, v109
    v_cvt_pk_bf16_f32 v197, v110, v111
    v_cvt_pk_bf16_f32 v198, v112, v113
    v_cvt_pk_bf16_f32 v199, v114, v115
    v_exp_f32 v116, v116
    s_nop 0
    v_mfma_f32_32x32x16_bf16 v[156:171], v[52:55], v[196:199], 0
    v_exp_f32 v117, v117
    v_exp_f32 v118, v118
    v_exp_f32 v119, v119
    v_exp_f32 v120, v120
    v_exp_f32 v121, v121
    v_exp_f32 v122, v122
    v_exp_f32 v123, v123
    v_cvt_pk_bf16_f32 v200, v116, v117
    v_cvt_pk_bf16_f32 v201, v118, v119
    v_cvt_pk_bf16_f32 v202, v120, v121
    v_cvt_pk_bf16_f32 v203, v122, v123
    v_exp_f32 v124, v124
    s_nop 0
    v_mfma_f32_32x32x16_bf16 v[156:171], v[56:59], v[200:203], v[156:171]
    v_exp_f32 v125, v125
    v_mfma_f32_32x32x16_bf16 v[108:123], v[28:31], v[192:195], v[140:155]
    v_exp_f32 v126, v126
    v_exp_f32 v127, v127
    v_exp_f32 v128, v128
    v_exp_f32 v129, v129
    v_exp_f32 v130, v130
    v_exp_f32 v131, v131
    v_cvt_pk_bf16_f32 v196, v124, v125
    v_cvt_pk_bf16_f32 v197, v126, v127
    v_cvt_pk_bf16_f32 v198, v128, v129
    v_cvt_pk_bf16_f32 v199, v130, v131
    v_exp_f32 v132, v132
    s_nop 0
    v_mfma_f32_32x32x16_bf16 v[156:171], v[60:63], v[196:199], v[156:171]
    v_exp_f32 v133, v133
    v_exp_f32 v134, v134
    v_exp_f32 v135, v135
    v_exp_f32 v136, v136
    v_exp_f32 v137, v137
    v_exp_f32 v138, v138
    v_exp_f32 v139, v139
    v_cvt_pk_bf16_f32 v200, v132, v133
    v_cvt_pk_bf16_f32 v201, v134, v135
    v_cvt_pk_bf16_f32 v202, v136, v137
    v_cvt_pk_bf16_f32 v203, v138, v139
    v_exp_f32 v108, v108
    s_nop 0
    v_mfma_f32_32x32x16_bf16 v[156:171], v[64:67], v[200:203], v[156:171]
    v_exp_f32 v109, v109
    v_mfma_f32_32x32x16_bf16 v[124:139], v[32:35], v[192:195], v[140:155]
    v_exp_f32 v110, v110
    v_exp_f32 v111, v111
    v_exp_f32 v112, v112
    v_exp_f32 v113, v113
    v_exp_f32 v114, v114
    v_exp_f32 v115, v115
    v_cvt_pk_bf16_f32 v196, v108, v109
    v_cvt_pk_bf16_f32 v197, v110, v111
    v_cvt_pk_bf16_f32 v198, v112, v113
    v_cvt_pk_bf16_f32 v199, v114, v115
    v_exp_f32 v116, v116
    s_nop 0
    v_mfma_f32_32x32x16_bf16 v[156:171], v[68:71], v[196:199], v[156:171]
    v_exp_f32 v117, v117
    v_exp_f32 v118, v118
    v_exp_f32 v119, v119
    v_exp_f32 v120, v120
    v_exp_f32 v121, v121
    v_exp_f32 v122, v122
    v_exp_f32 v123, v123
    v_cvt_pk_bf16_f32 v200, v116, v117
    v_cvt_pk_bf16_f32 v201, v118, v119
    v_cvt_pk_bf16_f32 v202, v120, v121
    v_cvt_pk_bf16_f32 v203, v122, v123
    v_exp_f32 v124, v124
    s_nop 0
    v_mfma_f32_32x32x16_bf16 v[156:171], v[72:75], v[200:203], v[156:171]
    v_exp_f32 v125, v125
    v_exp_f32 v126, v126
    v_exp_f32 v127, v127
    v_cvt_pk_bf16_f32 v196, v124, v125
    v_cvt_pk_bf16_f32 v197, v126, v127
    v_mov_b32 v198, 0
    v_mov_b32 v199, 0
    s_nop 1
    v_mfma_f32_32x32x16_bf16 v[156:171], v[76:79], v[196:199], v[156:171]
    v_mov_b32 v216, 0x21800000
    s_nop 10
    v_cmp_nle_f32 vcc, v216, v164
    s_cbranch_vccnz L_fb_4
    v_rcp_f32 v216, v164
    s_add_u32 s47, s28, 896
    v_fma_f32 v212, v160, v216, v208
    v_fma_f32 v213, v161, v216, v209
    v_fma_f32 v214, v162, v216, v210
    v_fma_f32 v215, v163, v216, v211
    v_cvt_pk_bf16_f32 v212, v212, v213
    v_cvt_pk_bf16_f32 v213, v214, v215
    v_pk_max_i16 v212, v212, 0
    v_pk_max_i16 v213, v213, 0
    buffer_store_dwordx2 v[212:213], v5, s[8:11], s47 offen offset:16
L_after_4:
    s_waitcnt vmcnt(2)
    v_mfma_f32_32x32x16_bf16 v[140:155], v[236:239], v[220:223], 0
    v_mfma_f32_32x32x16_bf16 v[156:171], v[220:223], v[240:243], 0
    v_mfma_f32_32x32x16_bf16 v[172:187], v[236:239], v[224:227], 0
    v_mfma_f32_32x32x16_bf16 v[108:123], v[224:227], v[240:243], 0
    s_nop 8
    v_cvt_pk_bf16_f32 v36, v140, v141
    v_cvt_pk_bf16_f32 v37, v142, v143
    v_cvt_pk_bf16_f32 v38, v144, v145
    v_cvt_pk_bf16_f32 v39, v146, v147
    v_mul_f32 v246, v140, v140
    v_mul_f32 v247, v148, v148
    v_fmac_f32 v246, v141, v141
    v_fmac_f32 v247, v149, v149
    v_fmac_f32 v246, v142, v142
    v_fmac_f32 v247, v150, v150
    v_fmac_f32 v246, v143, v143
    v_fmac_f32 v247, v151, v151
    v_fmac_f32 v246, v144, v144
    v_fmac_f32 v247, v152, v152
    v_fmac_f32 v246, v145, v145
    v_fmac_f32 v247, v153, v153
    v_fmac_f32 v246, v146, v146
    v_fmac_f32 v247, v154, v154
    v_fmac_f32 v246, v147, v147
    v_fmac_f32 v247, v155, v155
    v_mov_b32 v244, v246
    v_mov_b32 v245, v247
    v_cvt_pk_bf16_f32 v80, v156, v157
    v_cvt_pk_bf16_f32 v81, v158, v159
    v_cvt_pk_bf16_f32 v82, v160, v161
    v_cvt_pk_bf16_f32 v83, v162, v163
    v_cvt_pk_bf16_f32 v84, v164, v165
    v_cvt_pk_bf16_f32 v85, v166, v167
    v_cvt_pk_bf16_f32 v86, v168, v169
    v_cvt_pk_bf16_f32 v87, v170, v171
    v_or_b32 v80, v80, v6
    v_or_b32 v81, v81, v6
    v_or_b32 v82, v82, v6
    v_or_b32 v83, v83, v6
    v_or_b32 v84, v84, v6
    v_or_b32 v85, v85, v6
    v_or_b32 v86, v86, v6
    v_or_b32 v87, v87, v6
    v_mfma_f32_32x32x16_bf16 v[140:155], v[236:239], v[228:231], 0
    v_mfma_f32_32x32x16_bf16 v[156:171], v[228:231], v[240:243], 0
    v_cvt_pk_bf16_f32 v40, v172, v173
    v_cvt_pk_bf16_f32 v41, v174, v175
    v_cvt_pk_bf16_f32 v42, v176, v177
    v_cvt_pk_bf16_f32 v43, v178, v179
    v_mul_f32 v246, v172, v172
    v_mul_f32 v247, v180, v180
    v_fmac_f32 v246, v173, v173
    v_fmac_f32 v247, v181, v181
    v_fmac_f32 v246, v174, v174
    v_fmac_f32 v247, v182, v182
    v_fmac_f32 v246, v175, v175
    v_fmac_f32 v247, v183, v183
    v_fmac_f32 v246, v176, v176
    v_fmac_f32 v247, v184, v184
    v_fmac_f32 v246, v177, v177
    v_fmac_f32 v247, v185, v185
    v_fmac_f32 v246, v178, v178
    v_fmac_f32 v247, v186, v186
    v_fmac_f32 v246, v179, v179
    v_fmac_f32 v247, v187, v187
    v_max_f32 v244, v244, v246
    v_max_f32 v245, v245, v247
    v_cvt_pk_bf16_f32 v88, v108, v109
    v_cvt_pk_bf16_f32 v89, v110, v111
    v_cvt_pk_bf16_f32 v90, v112, v113
    v_cvt_pk_bf16_f32 v91, v114, v115
    v_cvt_pk_bf16_f32 v92, v116, v117
    v_cvt_pk_bf16_f32 v93, v118, v119
    v_cvt_pk_bf16_f32 v94, v120, v121
    v_cvt_pk_bf16_f32 v95, v122, v123
    v_or_b32 v88, v88, v6
    v_or_b32 v89, v89, v6
    v_or_b32 v90, v90, v6
    v_or_b32 v91, v91, v6
    v_or_b32 v92, v92, v6
    v_or_b32 v93, v93, v6
    v_or_b32 v94, v94, v6
    v_or_b32 v95, v95, v6
    v_mfma_f32_32x32x16_bf16 v[172:187], v[236:239], v[232:235], 0
    v_mfma_f32_32x32x16_bf16 v[108:123], v[232:235], v[240:243], 0
    v_cvt_pk_bf16_f32 v44, v140, v141
    v_cvt_pk_bf16_f32 v45, v142, v143
    v_cvt_pk_bf16_f32 v46, v144, v145
    v_cvt_pk_bf16_f32 v47, v146, v147
    v_mul_f32 v246, v140, v140
    v_mul_f32 v247, v148, v148
    v_fmac_f32 v246, v141, v141
    v_fmac_f32 v247, v149, v149
    v_fmac_f32 v246, v142, v142
    v_fmac_f32 v247, v150, v150
    v_fmac_f32 v246, v143, v143
    v_fmac_f32 v247, v151, v151
    v_fmac_f32 v246, v144, v144
    v_fmac_f32 v247, v152, v152
    v_fmac_f32 v246, v145, v145
    v_fmac_f32 v247, v153, v153
    v_fmac_f32 v246, v146, v146
    v_fmac_f32 v247, v154, v154
    v_fmac_f32 v246, v147, v147
    v_fmac_f32 v247, v155, v155
    v_max_f32 v244, v244, v246
    v_max_f32 v245, v245, v247
    v_cvt_pk_bf16_f32 v96, v156, v157
    v_cvt_pk_bf16_f32 v97, v158, v159
    v_cvt_pk_bf16_f32 v98, v160, v161
    v_cvt_pk_bf16_f32 v99, v162, v163
    v_cvt_pk_bf16_f32 v100, v164, v165
    v_cvt_pk_bf16_f32 v101, v166, v167
    v_cvt_pk_bf16_f32 v102, v168, v169
    v_cvt_pk_bf16_f32 v103, v170, v171
    v_or_b32 v96, v96, v6
    v_or_b32 v97, v97, v6
    v_or_b32 v98, v98, v6
    v_or_b32 v99, v99, v6
    v_or_b32 v100, v100, v6
    v_or_b32 v101, v101, v6
    v_or_b32 v102, v102, v6
    v_or_b32 v103, v103, v6
    v_cvt_pk_bf16_f32 v48, v172, v173
    v_cvt_pk_bf16_f32 v49, v174, v175
    v_cvt_pk_bf16_f32 v50, v176, v177
    v_cvt_pk_bf16_f32 v51, v178, v179
    v_mul_f32 v246, v172, v172
    v_mul_f32 v247, v180, v180
    v_fmac_f32 v246, v173, v173
    v_fmac_f32 v247, v181, v181
    v_fmac_f32 v246, v174, v174
    v_fmac_f32 v247, v182, v182
    v_fmac_f32 v246, v175, v175
    v_fmac_f32 v247, v183, v183
    v_fmac_f32 v246, v176, v176
    v_fmac_f32 v247, v184, v184
    v_fmac_f32 v246, v177, v177
    v_fmac_f32 v247, v185, v185
    v_fmac_f32 v246, v178, v178
    v_fmac_f32 v247, v186, v186
    v_fmac_f32 v246, v179, v179
    v_fmac_f32 v247, v187, v187
    v_max_f32 v244, v244, v246
    v_max_f32 v245, v245, v247
    v_cvt_pk_bf16_f32 v104, v108, v109
    v_cvt_pk_bf16_f32 v105, v110, v111
    v_or_b32 v104, v104, v6
    v_and_b32 v104, v104, v7
    v_or_b32 v105, v105, v6
    v_and_b32 v105, v105, v7
    v_mov_b32 v106, 0
    v_mov_b32 v107, 0
    v_max_f32_dpp v244, v244, v244 row_ror:8 row_mask:0xf bank_mask:0xf
    s_nop 1
    v_max_f32_dpp v244, v244, v244 row_ror:4 row_mask:0xf bank_mask:0xf
    s_nop 1
    v_max_f32_dpp v244, v244, v244 row_ror:2 row_mask:0xf bank_mask:0xf
    s_nop 1
    v_max_f32_dpp v244, v244, v244 row_ror:1 row_mask:0xf bank_mask:0xf
    v_mov_b32 v213, v244
    s_nop 1
    v_permlane16_swap_b32 v244, v213
    v_max_f32 v244, v244, v213
    v_max_f32_dpp v245, v245, v245 row_ror:8 row_mask:0xf bank_mask:0xf
    s_nop 1
    v_max_f32_dpp v245, v245, v245 row_ror:4 row_mask:0xf bank_mask:0xf
    s_nop 1
    v_max_f32_dpp v245, v245, v245 row_ror:2 row_mask:0xf bank_mask:0xf
    s_nop 1
    v_max_f32_dpp v245, v245, v245 row_ror:1 row_mask:0xf bank_mask:0xf
    v_mov_b32 v213, v245
    s_nop 1
    v_permlane16_swap_b32 v245, v213
    v_max_f32 v245, v245, v213
    v_mul_f32 v244, v244, v245
    v_sqrt_f32 v244, v244
    v_mov_b32 v213, 0xbf820000
    v_mul_f32 v244, v213, v244
    v_mov_b32 v19, v244
    v_mov_b32 v18, v244
    s_nop 1
    v_permlane32_swap_b32 v18, v19
    s_waitcnt vmcnt(1)
    v_mfma_f32_32x32x16_bf16 v[172:187], v[12:15], v[188:191], 0
    s_add_u32 s46, s28, 2944
    buffer_load_dwordx4 v[188:191], v3, s[4:7], s46 offen
    v_mov_b32 v140, v17
    v_mov_b32 v141, v17
    v_mov_b32 v142, v17
    v_mov_b32 v143, v17
    v_mov_b32 v144, v17
    v_mov_b32 v145, v17
    v_mov_b32 v146, v17
    v_mov_b32 v147, v17
    v_mov_b32 v148, v17
    v_mov_b32 v149, v17
    v_mov_b32 v150, v17
    v_mov_b32 v151, v17
    v_mov_b32 v152, v17
    v_mov_b32 v153, v17
    v_mov_b32 v154, v17
    v_mov_b32 v155, v17
    v_cvt_pk_bf16_f32 v204, v172, v173
    v_cvt_pk_bf16_f32 v205, v174, v175
    v_cvt_pk_bf16_f32 v206, v176, v177
    v_cvt_pk_bf16_f32 v207, v178, v179
    v_and_b32 v204, v204, v8
    v_and_b32 v205, v205, v8
    v_and_b32 v206, v206, v8
    v_and_b32 v207, v207, v8
    v_mov_b32 v244, v184
    v_mov_b32 v245, v185
    v_mov_b32 v246, v186
    v_mov_b32 v247, v187
    v_mfma_f32_32x32x16_bf16 v[108:123], v[20:23], v[204:207], v[140:155]
    v_mfma_f32_32x32x16_bf16 v[124:139], v[24:27], v[204:207], v[140:155]
L_p2_5:
    s_nop 10
    v_exp_f32 v108, v108
    v_exp_f32 v109, v109
    v_exp_f32 v110, v110
    v_exp_f32 v111, v111
    v_exp_f32 v112, v112
    v_exp_f32 v113, v113
    v_exp_f32 v114, v114
    v_exp_f32 v115, v115
    v_cvt_pk_bf16_f32 v196, v108, v109
    v_cvt_pk_bf16_f32 v197, v110, v111
    v_cvt_pk_bf16_f32 v198, v112, v113
    v_cvt_pk_bf16_f32 v199, v114, v115
    v_exp_f32 v116, v116
    s_nop 0
    v_mfma_f32_32x32x16_bf16 v[156:171], v[52:55], v[196:199], 0
    v_exp_f32 v117, v117
    v_exp_f32 v118, v118
    v_exp_f32 v119, v119
    v_exp_f32 v120, v120
    v_exp_f32 v121, v121
    v_exp_f32 v122, v122
    v_exp_f32 v123, v123
    v_cvt_pk_bf16_f32 v200, v116, v117
    v_cvt_pk_bf16_f32 v201, v118, v119
    v_cvt_pk_bf16_f32 v202, v120, v121
    v_cvt_pk_bf16_f32 v203, v122, v123
    v_exp_f32 v124, v124
    s_nop 0
    v_mfma_f32_32x32x16_bf16 v[156:171], v[56:59], v[200:203], v[156:171]
    v_exp_f32 v125, v125
    v_mfma_f32_32x32x16_bf16 v[108:123], v[28:31], v[204:207], v[140:155]
    v_exp_f32 v126, v126
    v_exp_f32 v127, v127
    v_exp_f32 v128, v128
    v_exp_f32 v129, v129
    v_exp_f32 v130, v130
    v_exp_f32 v131, v131
    v_cvt_pk_bf16_f32 v196, v124, v125
    v_cvt_pk_bf16_f32 v197, v126, v127
    v_cvt_pk_bf16_f32 v198, v128, v129
    v_cvt_pk_bf16_f32 v199, v130, v131
    v_exp_f32 v132, v132
    s_nop 0
    v_mfma_f32_32x32x16_bf16 v[156:171], v[60:63], v[196:199], v[156:171]
    v_exp_f32 v133, v133
    v_exp_f32 v134, v134
    v_exp_f32 v135, v135
    v_exp_f32 v136, v136
    v_exp_f32 v137, v137
    v_exp_f32 v138, v138
    v_exp_f32 v139, v139
    v_cvt_pk_bf16_f32 v200, v132, v133
    v_cvt_pk_bf16_f32 v201, v134, v135
    v_cvt_pk_bf16_f32 v202, v136, v137
    v_cvt_pk_bf16_f32 v203, v138, v139
    v_exp_f32 v108, v108
    s_nop 0
    v_mfma_f32_32x32x16_bf16 v[156:171], v[64:67], v[200:203], v[156:171]
    v_exp_f32 v109, v109
    v_mfma_f32_32x32x16_bf16 v[124:139], v[32:35], v[204:207], v[140:155]
    v_exp_f32 v110, v110
    v_exp_f32 v111, v111
    v_exp_f32 v112, v112
    v_exp_f32 v113, v113
    v_exp_f32 v114, v114
    v_exp_f32 v115, v115
    v_cvt_pk_bf16_f32 v196, v108, v109
    v_cvt_pk_bf16_f32 v197, v110, v111
    v_cvt_pk_bf16_f32 v198, v112, v113
    v_cvt_pk_bf16_f32 v199, v114, v115
    v_exp_f32 v116, v116
    s_nop 0
    v_mfma_f32_32x32x16_bf16 v[156:171], v[68:71], v[196:199], v[156:171]
    v_exp_f32 v117, v117
    v_exp_f32 v118, v118
    v_exp_f32 v119, v119
    v_exp_f32 v120, v120
    v_exp_f32 v121, v121
    v_exp_f32 v122, v122
    v_exp_f32 v123, v123
    v_cvt_pk_bf16_f32 v200, v116, v117
    v_cvt_pk_bf16_f32 v201, v118, v119
    v_cvt_pk_bf16_f32 v202, v120, v121
    v_cvt_pk_bf16_f32 v203, v122, v123
    v_exp_f32 v124, v124
    s_nop 0
    v_mfma_f32_32x32x16_bf16 v[156:171], v[72:75], v[200:203], v[156:171]
    v_exp_f32 v125, v125
    v_exp_f32 v126, v126
    v_exp_f32 v127, v127
    v_cvt_pk_bf16_f32 v196, v124, v125
    v_cvt_pk_bf16_f32 v197, v126, v127
    v_mov_b32 v198, 0
    v_mov_b32 v199, 0
    s_nop 1
    v_mfma_f32_32x32x16_bf16 v[156:171], v[76:79], v[196:199], v[156:171]
    v_mov_b32 v216, 0x21800000
    s_nop 10
    v_cmp_nle_f32 vcc, v216, v164
    s_cbranch_vccnz L_fb_5
    v_rcp_f32 v216, v164
    s_add_u32 s47, s28, 1920
    v_fma_f32 v212, v160, v216, v244
    v_fma_f32 v213, v161, v216, v245
    v_fma_f32 v214, v162, v216, v246
    v_fma_f32 v215, v163, v216, v247
    v_cvt_pk_bf16_f32 v212, v212, v213
    v_cvt_pk_bf16_f32 v213, v214, v215
    v_pk_max_i16 v212, v212, 0
    v_pk_max_i16 v213, v213, 0
    buffer_store_dwordx2 v[212:213], v5, s[8:11], s47 offen offset:16
L_after_5:
    v_cndmask_b32_e64 v20, v20, v36, s[44:45]
    v_cndmask_b32_e64 v21, v21, v37, s[44:45]
    v_cndmask_b32_e64 v22, v22, v38, s[44:45]
    v_cndmask_b32_e64 v23, v23, v39, s[44:45]
    v_cndmask_b32_e64 v24, v24, v40, s[44:45]
    v_cndmask_b32_e64 v25, v25, v41, s[44:45]
    v_cndmask_b32_e64 v26, v26, v42, s[44:45]
    v_cndmask_b32_e64 v27, v27, v43, s[44:45]
    v_cndmask_b32_e64 v28, v28, v44, s[44:45]
    v_cndmask_b32_e64 v29, v29, v45, s[44:45]
    v_cndmask_b32_e64 v30, v30, v46, s[44:45]
    v_cndmask_b32_e64 v31, v31, v47, s[44:45]
    v_cndmask_b32_e64 v32, v32, v48, s[44:45]
    v_cndmask_b32_e64 v33, v33, v49, s[44:45]
    v_cndmask_b32_e64 v34, v34, v50, s[44:45]
    v_cndmask_b32_e64 v35, v35, v51, s[44:45]
    v_cndmask_b32_e64 v52, v52, v80, s[42:43]
    v_cndmask_b32_e64 v53, v53, v81, s[42:43]
    v_cndmask_b32_e64 v54, v54, v82, s[42:43]
    v_cndmask_b32_e64 v55, v55, v83, s[42:43]
    v_cndmask_b32_e64 v56, v56, v84, s[42:43]
    v_cndmask_b32_e64 v57, v57, v85, s[42:43]
    v_cndmask_b32_e64 v58, v58, v86, s[42:43]
    v_cndmask_b32_e64 v59, v59, v87, s[42:43]
    v_cndmask_b32_e64 v60, v60, v88, s[42:43]
    v_cndmask_b32_e64 v61, v61, v89, s[42:43]
    v_cndmask_b32_e64 v62, v62, v90, s[42:43]
    v_cndmask_b32_e64 v63, v63, v91, s[42:43]
    v_cndmask_b32_e64 v64, v64, v92, s[42:43]
    v_cndmask_b32_e64 v65, v65, v93, s[42:43]
    v_cndmask_b32_e64 v66, v66, v94, s[42:43]
    v_cndmask_b32_e64 v67, v67, v95, s[42:43]
    v_cndmask_b32_e64 v68, v68, v96, s[42:43]
    v_cndmask_b32_e64 v69, v69, v97, s[42:43]
    v_cndmask_b32_e64 v70, v70, v98, s[42:43]
    v_cndmask_b32_e64 v71, v71, v99, s[42:43]
    v_cndmask_b32_e64 v72, v72, v100, s[42:43]
    v_cndmask_b32_e64 v73, v73, v101, s[42:43]
    v_cndmask_b32_e64 v74, v74, v102, s[42:43]
    v_cndmask_b32_e64 v75, v75, v103, s[42:43]
    v_cndmask_b32_e64 v76, v76, v104, s[42:43]
    v_cndmask_b32_e64 v77, v77, v105, s[42:43]
    v_cndmask_b32_e64 v78, v78, v106, s[42:43]
    v_cndmask_b32_e64 v79, v79, v107, s[42:43]
    v_cmp_le_u32 s[38:39], 8, v1
    s_waitcnt vmcnt(1)
    v_mfma_f32_32x32x16_bf16 v[172:187], v[12:15], v[188:191], 0
    s_add_u32 s46, s28, 3968
    buffer_load_dwordx4 v[188:191], v3, s[4:7], s46 offen
    v_cndmask_b32_e64 v216, v17, v18, s[38:39]
    v_mov_b32 v140, v216
    v_mov_b32 v141, v216
    v_mov_b32 v142, v216
    v_mov_b32 v143, v216
    v_mov_b32 v144, v216
    v_mov_b32 v145, v216
    v_mov_b32 v146, v216
    v_mov_b32 v147, v216
    v_mov_b32 v148, v216
    v_mov_b32 v149, v216
    v_mov_b32 v150, v216
    v_mov_b32 v151, v216
    v_mov_b32 v152, v216
    v_mov_b32 v153, v216
    v_mov_b32 v154, v216
    v_mov_b32 v155, v216
    v_cvt_pk_bf16_f32 v192, v172, v173
    v_cvt_pk_bf16_f32 v193, v174, v175
    v_cvt_pk_bf16_f32 v194, v176, v177
    v_cvt_pk_bf16_f32 v195, v178, v179
    v_cndmask_b32_e64 v217, v8, v7, s[38:39]
    v_and_b32 v192, v192, v217
    v_and_b32 v193, v193, v217
    v_and_b32 v194, v194, v217
    v_and_b32 v195, v195, v217
    v_cndmask_b32_e64 v208, v184, v180, s[38:39]
    v_cndmask_b32_e64 v209, v185, v181, s[38:39]
    v_cndmask_b32_e64 v210, v186, v182, s[38:39]
    v_cndmask_b32_e64 v211, v187, v183, s[38:39]
    v_mfma_f32_32x32x16_bf16 v[108:123], v[20:23], v[192:195], v[140:155]
    v_mfma_f32_32x32x16_bf16 v[124:139], v[24:27], v[192:195], v[140:155]
L_p2_6:
    s_nop 10
    v_exp_f32 v108, v108
    v_exp_f32 v109, v109
    v_exp_f32 v110, v110
    v_exp_f32 v111, v111
    v_exp_f32 v112, v112
    v_exp_f32 v113, v113
    v_exp_f32 v114, v114
    v_exp_f32 v115, v115
    v_cvt_pk_bf16_f32 v196, v108, v109
    v_cvt_pk_bf16_f32 v197, v110, v111
    v_cvt_pk_bf16_f32 v198, v112, v113
    v_cvt_pk_bf16_f32 v199, v114, v115
    v_exp_f32 v116, v116
    s_nop 0
    v_mfma_f32_32x32x16_bf16 v[156:171], v[52:55], v[196:199], 0
    v_exp_f32 v117, v117
    v_exp_f32 v118, v118
    v_exp_f32 v119, v119
    v_exp_f32 v120, v120
    v_exp_f32 v121, v121
    v_exp_f32 v122, v122
    v_exp_f32 v123, v123
    v_cvt_pk_bf16_f32 v200, v116, v117
    v_cvt_pk_bf16_f32 v201, v118, v119
    v_cvt_pk_bf16_f32 v202, v120, v121
    v_cvt_pk_bf16_f32 v203, v122, v123
    v_exp_f32 v124, v124
    s_nop 0
    v_mfma_f32_32x32x16_bf16 v[156:171], v[56:59], v[200:203], v[156:171]
    v_exp_f32 v125, v125
    v_mfma_f32_32x32x16_bf16 v[108:123], v[28:31], v[192:195], v[140:155]
    v_exp_f32 v126, v126
    s_waitcnt vmcnt(0)
    v_exp_f32 v127, v127
    v_mfma_f32_32x32x16_bf16 v[172:187], v[12:15], v[188:191], 0
    v_exp_f32 v128, v128
    s_add_u32 s46, s28, 4992
    v_exp_f32 v129, v129
    buffer_load_dwordx4 v[188:191], v3, s[4:7], s46 offen
    v_exp_f32 v130, v130
    v_exp_f32 v131, v131
    v_cvt_pk_bf16_f32 v196, v124, v125
    v_cvt_pk_bf16_f32 v197, v126, v127
    v_cvt_pk_bf16_f32 v198, v128, v129
    v_cvt_pk_bf16_f32 v199, v130, v131
    v_exp_f32 v132, v132
    s_nop 0
    v_mfma_f32_32x32x16_bf16 v[156:171], v[60:63], v[196:199], v[156:171]
    v_exp_f32 v133, v133
    v_exp_f32 v134, v134
    v_exp_f32 v135, v135
    v_exp_f32 v136, v136
    v_exp_f32 v137, v137
    v_exp_f32 v138, v138
    v_exp_f32 v139, v139
    v_cvt_pk_bf16_f32 v200, v132, v133
    v_cvt_pk_bf16_f32 v201, v134, v135
    v_cvt_pk_bf16_f32 v202, v136, v137
    v_cvt_pk_bf16_f32 v203, v138, v139
    v_exp_f32 v108, v108
    s_nop 0
    v_mfma_f32_32x32x16_bf16 v[156:171], v[64:67], v[200:203], v[156:171]
    v_exp_f32 v109, v109
    v_mfma_f32_32x32x16_bf16 v[124:139], v[32:35], v[192:195], v[140:155]
    v_exp_f32 v110, v110
    v_cvt_pk_bf16_f32 v204, v172, v173
    v_exp_f32 v111, v111
    v_cvt_pk_bf16_f32 v205, v174, v175
    v_exp_f32 v112, v112
    v_cvt_pk_bf16_f32 v206, v176, v177
    v_exp_f32 v113, v113
    v_cvt_pk_bf16_f32 v207, v178, v179
    v_exp_f32 v114, v114
    v_and_b32 v204, v204, v7
    v_exp_f32 v115, v115
    v_and_b32 v205, v205, v7
    v_cvt_pk_bf16_f32 v196, v108, v109
    v_cvt_pk_bf16_f32 v197, v110, v111
    v_cvt_pk_bf16_f32 v198, v112, v113
    v_cvt_pk_bf16_f32 v199, v114, v115
    v_exp_f32 v116, v116
    s_nop 0
    v_mfma_f32_32x32x16_bf16 v[156:171], v[68:71], v[196:199], v[156:171]
    v_exp_f32 v117, v117
    v_and_b32 v206, v206, v7
    v_exp_f32 v118, v118
    v_and_b32 v207, v207, v7
    v_exp_f32 v119, v119
    v_mov_b32 v244, v180
    v_exp_f32 v120, v120
    v_mov_b32 v245, v181
    v_exp_f32 v121, v121
    v_mov_b32 v246, v182
    v_exp_f32 v122, v122
    v_mov_b32 v247, v183
    v_exp_f32 v123, v123
    v_mov_b32 v140, v18
    v_cvt_pk_bf16_f32 v200, v116, v117
    v_cvt_pk_bf16_f32 v201, v118, v119
    v_cvt_pk_bf16_f32 v202, v120, v121
    v_cvt_pk_bf16_f32 v203, v122, v123
    v_exp_f32 v124, v124
    s_nop 0
    v_mfma_f32_32x32x16_bf16 v[156:171], v[72:75], v[200:203], v[156:171]
    v_exp_f32 v125, v125
    v_mov_b32 v141, v18
    v_exp_f32 v126, v126
    v_mov_b32 v142, v18
    v_exp_f32 v127, v127
    v_mov_b32 v143, v18
    v_cvt_pk_bf16_f32 v196, v124, v125
    v_cvt_pk_bf16_f32 v197, v126, v127
    v_mov_b32 v198, 0
    v_mov_b32 v199, 0
    s_nop 1
    v_mfma_f32_32x32x16_bf16 v[156:171], v[76:79], v[196:199], v[156:171]
    v_mov_b32 v144, v18
    v_mov_b32 v145, v18
    v_mov_b32 v146, v18
    v_mov_b32 v147, v18
    v_mov_b32 v148, v18
    v_mov_b32 v149, v18
    v_mov_b32 v150, v18
    v_mov_b32 v151, v18
    v_mov_b32 v152, v18
    v_mov_b32 v153, v18
    v_mov_b32 v154, v18
    v_mov_b32 v155, v18
    s_nop 1
    v_mfma_f32_32x32x16_bf16 v[108:123], v[36:39], v[204:207], v[140:155]
    v_mfma_f32_32x32x16_bf16 v[124:139], v[40:43], v[204:207], v[140:155]
    v_mov_b32 v216, 0x21800000
    v_cmp_nle_f32 vcc, v216, v164
    s_cbranch_vccnz L_fb_6
    v_rcp_f32 v216, v164
    v_cndmask_b32_e64 v212, v160, v156, s[38:39]
    v_cndmask_b32_e64 v213, v161, v157, s[38:39]
    v_cndmask_b32_e64 v214, v162, v158, s[38:39]
    v_cndmask_b32_e64 v215, v163, v159, s[38:39]
    v_mov_b32 v217, 2944
    v_mov_b32 v218, 0xb70
    v_cndmask_b32_e64 v217, v217, v218, s[38:39]
    v_add_u32 v217, v5, v217
    v_fma_f32 v212, v212, v216, v208
    v_fma_f32 v213, v213, v216, v209
    v_fma_f32 v214, v214, v216, v210
    v_fma_f32 v215, v215, v216, v211
    v_cvt_pk_bf16_f32 v212, v212, v213
    v_cvt_pk_bf16_f32 v213, v214, v215
    v_pk_max_i16 v212, v212, 0
    v_pk_max_i16 v213, v213, 0
    buffer_store_dwordx2 v[212:213], v217, s[8:11], s28 offen offset:16
L_after_6:
L_p2_7:
    v_exp_f32 v108, v108
    v_exp_f32 v109, v109
    v_exp_f32 v110, v110
    v_exp_f32 v111, v111
    v_exp_f32 v112, v112
    v_exp_f32 v113, v113
    v_exp_f32 v114, v114
    v_exp_f32 v115, v115
    v_cvt_pk_bf16_f32 v196, v108, v109
    v_cvt_pk_bf16_f32 v197, v110, v111
    v_cvt_pk_bf16_f32 v198, v112, v113
    v_cvt_pk_bf16_f32 v199, v114, v115
    v_exp_f32 v116, v116
    s_nop 0
    v_mfma_f32_32x32x16_bf16 v[156:171], v[80:83], v[196:199], 0
    v_exp_f32 v117, v117
    v_exp_f32 v118, v118
    v_exp_f32 v119, v119
    v_exp_f32 v120, v120
    v_exp_f32 v121, v121
    v_exp_f32 v122, v122
    v_exp_f32 v123, v123
    v_cvt_pk_bf16_f32 v200, v116, v117
    v_cvt_pk_bf16_f32 v201, v118, v119
    v_cvt_pk_bf16_f32 v202, v120, v121
    v_cvt_pk_bf16_f32 v203, v122, v123
    v_exp_f32 v124, v124
    s_nop 0
    v_mfma_f32_32x32x16_bf16 v[156:171], v[84:87], v[200:203], v[156:171]
    v_exp_f32 v125, v125
    v_mfma_f32_32x32x16_bf16 v[108:123], v[44:47], v[204:207], v[140:155]
    v_exp_f32 v126, v126
    s_waitcnt vmcnt(1)
    v_exp_f32 v127, v127
    v_mfma_f32_32x32x16_bf16 v[172:187], v[12:15], v[188:191], 0
    v_exp_f32 v128, v128
    v_cmp_le_u32 s[40:41], 12, v1
    v_exp_f32 v129, v129
    v_mov_b32 v212, 6016
    v_exp_f32 v130, v130
    v_mov_b32 v213, 2816
    v_exp_f32 v131, v131
    v_cndmask_b32_e64 v212, v212, v213, s[40:41]
    v_cvt_pk_bf16_f32 v196, v124, v125
    v_cvt_pk_bf16_f32 v197, v126, v127
    v_cvt_pk_bf16_f32 v198, v128, v129
    v_cvt_pk_bf16_f32 v199, v130, v131
    v_exp_f32 v132, v132
    s_nop 0
    v_mfma_f32_32x32x16_bf16 v[156:171], v[88:91], v[196:199], v[156:171]
    v_exp_f32 v133, v133
    v_add_u32 v212, v3, v212
    v_exp_f32 v134, v134
    buffer_load_dwordx4 v[188:191], v212, s[4:7], s28 offen
    v_exp_f32 v135, v135
    v_exp_f32 v136, v136
    v_exp_f32 v137, v137
    v_exp_f32 v138, v138
    v_exp_f32 v139, v139
    v_cvt_pk_bf16_f32 v200, v132, v133
    v_cvt_pk_bf16_f32 v201, v134, v135
    v_cvt_pk_bf16_f32 v202, v136, v137
    v_cvt_pk_bf16_f32 v203, v138, v139
    v_exp_f32 v108, v108
    s_nop 0
    v_mfma_f32_32x32x16_bf16 v[156:171], v[92:95], v[200:203], v[156:171]
    v_exp_f32 v109, v109
    v_mfma_f32_32x32x16_bf16 v[124:139], v[48:51], v[204:207], v[140:155]
    v_exp_f32 v110, v110
    v_cvt_pk_bf16_f32 v192, v172, v173
    v_exp_f32 v111, v111
    v_cvt_pk_bf16_f32 v193, v174, v175
    v_exp_f32 v112, v112
    v_cvt_pk_bf16_f32 v194, v176, v177
    v_exp_f32 v113, v113
    v_cvt_pk_bf16_f32 v195, v178, v179
    v_exp_f32 v114, v114
    v_and_b32 v192, v192, v7
    v_exp_f32 v115, v115
    v_and_b32 v193, v193, v7
    v_cvt_pk_bf16_f32 v196, v108, v109
    v_cvt_pk_bf16_f32 v197, v110, v111
    v_cvt_pk_bf16_f32 v198, v112, v113
    v_cvt_pk_bf16_f32 v199, v114, v115
    v_exp_f32 v116, v116
    s_nop 0
    v_mfma_f32_32x32x16_bf16 v[156:171], v[96:99], v[196:199], v[156:171]
    v_exp_f32 v117, v117
    v_and_b32 v194, v194, v7
    v_exp_f32 v118, v118
    v_and_b32 v195, v195, v7
    v_exp_f32 v119, v119
    v_mov_b32 v208, v180
    v_exp_f32 v120, v120
    v_mov_b32 v209, v181
    v_exp_f32 v121, v121
    v_mov_b32 v210, v182
    v_exp_f32 v122, v122
    v_mov_b32 v211, v183
    v_exp_f32 v123, v123
    v_cvt_pk_bf16_f32 v200, v116, v117
    v_cvt_pk_bf16_f32 v201, v118, v119
    v_cvt_pk_bf16_f32 v202, v120, v121
    v_cvt_pk_bf16_f32 v203, v122, v123
    v_exp_f32 v124, v124
    s_nop 0
    v_mfma_f32_32x32x16_bf16 v[156:171], v[100:103], v[200:203], v[156:171]
    v_exp_f32 v125, v125
    v_exp_f32 v126, v126
    v_exp_f32 v127, v127
    v_cvt_pk_bf16_f32 v196, v124, v125
    v_cvt_pk_bf16_f32 v197, v126, v127
    v_mov_b32 v198, 0
    v_mov_b32 v199, 0
    s_nop 1
    v_mfma_f32_32x32x16_bf16 v[156:171], v[104:107], v[196:199], v[156:171]
    v_mfma_f32_32x32x16_bf16 v[108:123], v[36:39], v[192:195], v[140:155]
    v_mfma_f32_32x32x16_bf16 v[124:139], v[40:43], v[192:195], v[140:155]
    v_mov_b32 v216, 0x21800000
    s_nop 8
    v_cmp_nle_f32 vcc, v216, v164
    s_cbranch_vccnz L_fb_7
    v_rcp_f32 v216, v164
    s_add_u32 s47, s28, 3968
    v_fma_f32 v212, v156, v216, v244
    v_fma_f32 v213, v157, v216, v245
    v_fma_f32 v214, v158, v216, v246
    v_fma_f32 v215, v159, v216, v247
    v_cvt_pk_bf16_f32 v212, v212, v213
    v_cvt_pk_bf16_f32 v213, v214, v215
    v_pk_max_i16 v212, v212, 0
    v_pk_max_i16 v213, v213, 0
    buffer_store_dwordx2 v[212:213], v5, s[8:11], s47 offen offset:0
L_after_7:
L_p2_8:
    v_exp_f32 v108, v108
    v_exp_f32 v109, v109
    v_exp_f32 v110, v110
    v_exp_f32 v111, v111
    v_exp_f32 v112, v112
    v_exp_f32 v113, v113
    v_exp_f32 v114, v114
    v_exp_f32 v115, v115
    v_cvt_pk_bf16_f32 v196, v108, v109
    v_cvt_pk_bf16_f32 v197, v110, v111
    v_cvt_pk_bf16_f32 v198, v112, v113
    v_cvt_pk_bf16_f32 v199, v114, v115
    v_exp_f32 v116, v116
    s_nop 0
    v_mfma_f32_32x32x16_bf16 v[156:171], v[80:83], v[196:199], 0
    v_exp_f32 v117, v117
    v_exp_f32 v118, v118
    v_exp_f32 v119, v119
    v_exp_f32 v120, v120
    v_exp_f32 v121, v121
    v_exp_f32 v122, v122
    v_exp_f32 v123, v123
    v_cvt_pk_bf16_f32 v200, v116, v117
    v_cvt_pk_bf16_f32 v201, v118, v119
    v_cvt_pk_bf16_f32 v202, v120, v121
    v_cvt_pk_bf16_f32 v203, v122, v123
    v_exp_f32 v124, v124
    s_nop 0
    v_mfma_f32_32x32x16_bf16 v[156:171], v[84:87], v[200:203], v[156:171]
    v_exp_f32 v125, v125
    v_mfma_f32_32x32x16_bf16 v[108:123], v[44:47], v[192:195], v[140:155]
    v_exp_f32 v126, v126
    s_waitcnt vmcnt(1)
    v_exp_f32 v127, v127
    v_mfma_f32_32x32x16_bf16 v[172:187], v[12:15], v[188:191], 0
    v_exp_f32 v128, v128
    s_add_u32 s46, s28, 3840
    v_exp_f32 v129, v129
    buffer_load_dwordx4 v[188:191], v3, s[4:7], s46 offen
    v_exp_f32 v130, v130
    v_exp_f32 v131, v131
    v_cvt_pk_bf16_f32 v196, v124, v125
    v_cvt_pk_bf16_f32 v197, v126, v127
    v_cvt_pk_bf16_f32 v198, v128, v129
    v_cvt_pk_bf16_f32 v199, v130, v131
    v_exp_f32 v132, v132
    s_nop 0
    v_mfma_f32_32x32x16_bf16 v[156:171], v[88:91], v[196:199], v[156:171]
    v_exp_f32 v133, v133
    v_exp_f32 v134, v134
    v_exp_f32 v135, v135
    v_exp_f32 v136, v136
    v_exp_f32 v137, v137
    v_exp_f32 v138, v138
    v_exp_f32 v139, v139
    v_cvt_pk_bf16_f32 v200, v132, v133
    v_cvt_pk_bf16_f32 v201, v134, v135
    v_cvt_pk_bf16_f32 v202, v136, v137
    v_cvt_pk_bf16_f32 v203, v138, v139
    v_exp_f32 v108, v108
    s_nop 0
    v_mfma_f32_32x32x16_bf16 v[156:171], v[92:95], v[200:203], v[156:171]
    v_exp_f32 v109, v109
    v_mfma_f32_32x32x16_bf16 v[124:139], v[48:51], v[192:195], v[140:155]
    v_exp_f32 v110, v110
    v_cmp_le_u32 s[38:39], 12, v1
    v_exp_f32 v111, v111
    v_cvt_pk_bf16_f32 v204, v172, v173
    v_exp_f32 v112, v112
    v_cvt_pk_bf16_f32 v205, v174, v175
    v_exp_f32 v113, v113
    v_cvt_pk_bf16_f32 v206, v176, v177
    v_exp_f32 v114, v114
    v_cvt_pk_bf16_f32 v207, v178, v179
    v_exp_f32 v115, v115
    v_cndmask_b32_e64 v217, v7, v8, s[38:39]
    v_cvt_pk_bf16_f32 v196, v108, v109
    v_cvt_pk_bf16_f32 v197, v110, v111
    v_cvt_pk_bf16_f32 v198, v112, v113
    v_cvt_pk_bf16_f32 v199, v114, v115
    v_exp_f32 v116, v116
    s_nop 0
    v_mfma_f32_32x32x16_bf16 v[156:171], v[96:99], v[196:199], v[156:171]
    v_exp_f32 v117, v117
    v_and_b32 v204, v204, v217
    v_exp_f32 v118, v118
    v_and_b32 v205, v205, v217
    v_exp_f32 v119, v119
    v_and_b32 v206, v206, v217
    v_exp_f32 v120, v120
    v_and_b32 v207, v207, v217
    v_exp_f32 v121, v121
    v_cndmask_b32_e64 v244, v180, v184, s[38:39]
    v_exp_f32 v122, v122
    v_cndmask_b32_e64 v245, v181, v185, s[38:39]
    v_exp_f32 v123, v123
    v_cndmask_b32_e64 v246, v182, v186, s[38:39]
    v_cvt_pk_bf16_f32 v200, v116, v117
    v_cvt_pk_bf16_f32 v201, v118, v119
    v_cvt_pk_bf16_f32 v202, v120, v121
    v_cvt_pk_bf16_f32 v203, v122, v123
    v_exp_f32 v124, v124
    s_nop 0
    v_mfma_f32_32x32x16_bf16 v[156:171], v[100:103], v[200:203], v[156:171]
    v_exp_f32 v125, v125
    v_cndmask_b32_e64 v247, v183, v187, s[38:39]
    v_exp_f32 v126, v126
    v_cndmask_b32_e64 v216, v18, v19, s[38:39]
    v_exp_f32 v127, v127
    v_mov_b32 v140, v216
    v_cvt_pk_bf16_f32 v196, v124, v125
    v_cvt_pk_bf16_f32 v197, v126, v127
    v_mov_b32 v198, 0
    v_mov_b32 v199, 0
    s_nop 1
    v_mfma_f32_32x32x16_bf16 v[156:171], v[104:107], v[196:199], v[156:171]
    v_mov_b32 v141, v216
    v_mov_b32 v142, v216
    v_mov_b32 v143, v216
    v_mov_b32 v144, v216
    v_mov_b32 v145, v216
    v_mov_b32 v146, v216
    v_mov_b32 v147, v216
    v_mov_b32 v148, v216
    v_mov_b32 v149, v216
    v_mov_b32 v150, v216
    v_mov_b32 v151, v216
    v_mov_b32 v152, v216
    v_mov_b32 v153, v216
    v_mov_b32 v154, v216
    v_mov_b32 v155, v216
    s_nop 1
    v_mfma_f32_32x32x16_bf16 v[108:123], v[36:39], v[204:207], v[140:155]
    v_mfma_f32_32x32x16_bf16 v[124:139], v[40:43], v[204:207], v[140:155]
    v_mov_b32 v216, 0x21800000
    v_cmp_nle_f32 vcc, v216, v164
    s_cbranch_vccnz L_fb_8
    v_rcp_f32 v216, v164
    s_add_u32 s47, s28, 4992
    v_fma_f32 v212, v156, v216, v208
    v_fma_f32 v213, v157, v216, v209
    v_fma_f32 v214, v158, v216, v210
    v_fma_f32 v215, v159, v216, v211
    v_cvt_pk_bf16_f32 v212, v212, v213
    v_cvt_pk_bf16_f32 v213, v214, v215
    v_pk_max_i16 v212, v212, 0
    v_pk_max_i16 v213, v213, 0
    buffer_store_dwordx2 v[212:213], v5, s[8:11], s47 offen offset:0
L_after_8:
L_p2_9:
    v_exp_f32 v108, v108
    v_exp_f32 v109, v109
    v_exp_f32 v110, v110
    v_exp_f32 v111, v111
    v_exp_f32 v112, v112
    v_exp_f32 v113, v113
    v_exp_f32 v114, v114
    v_exp_f32 v115, v115
    v_cvt_pk_bf16_f32 v196, v108, v109
    v_cvt_pk_bf16_f32 v197, v110, v111
    v_cvt_pk_bf16_f32 v198, v112, v113
    v_cvt_pk_bf16_f32 v199, v114, v115
    v_exp_f32 v116, v116
    s_nop 0
    v_mfma_f32_32x32x16_bf16 v[156:171], v[80:83], v[196:199], 0
    v_exp_f32 v117, v117
    v_exp_f32 v118, v118
    v_exp_f32 v119, v119
    v_exp_f32 v120, v120
    v_exp_f32 v121, v121
    v_exp_f32 v122, v122
    v_exp_f32 v123, v123
    v_cvt_pk_bf16_f32 v200, v116, v117
    v_cvt_pk_bf16_f32 v201, v118, v119
    v_cvt_pk_bf16_f32 v202, v120, v121
    v_cvt_pk_bf16_f32 v203, v122, v123
    v_exp_f32 v124, v124
    s_nop 0
    v_mfma_f32_32x32x16_bf16 v[156:171], v[84:87], v[200:203], v[156:171]
    v_exp_f32 v125, v125
    v_mfma_f32_32x32x16_bf16 v[108:123], v[44:47], v[204:207], v[140:155]
    v_exp_f32 v126, v126
    s_waitcnt vmcnt(1)
    v_exp_f32 v127, v127
    v_mfma_f32_32x32x16_bf16 v[172:187], v[12:15], v[188:191], 0
    v_exp_f32 v128, v128
    s_add_u32 s46, s28, 4864
    v_exp_f32 v129, v129
    buffer_load_dwordx4 v[188:191], v3, s[4:7], s46 offen
    v_exp_f32 v130, v130
    v_exp_f32 v131, v131
    v_cvt_pk_bf16_f32 v196, v124, v125
    v_cvt_pk_bf16_f32 v197, v126, v127
    v_cvt_pk_bf16_f32 v198, v128, v129
    v_cvt_pk_bf16_f32 v199, v130, v131
    v_exp_f32 v132, v132
    s_nop 0
    v_mfma_f32_32x32x16_bf16 v[156:171], v[88:91], v[196:199], v[156:171]
    v_exp_f32 v133, v133
    v_exp_f32 v134, v134
    v_exp_f32 v135, v135
    v_exp_f32 v136, v136
    v_exp_f32 v137, v137
    v_exp_f32 v138, v138
    v_exp_f32 v139, v139
    v_cvt_pk_bf16_f32 v200, v132, v133
    v_cvt_pk_bf16_f32 v201, v134, v135
    v_cvt_pk_bf16_f32 v202, v136, v137
    v_cvt_pk_bf16_f32 v203, v138, v139
    v_exp_f32 v108, v108
    s_nop 0
    v_mfma_f32_32x32x16_bf16 v[156:171], v[92:95], v[200:203], v[156:171]
    v_exp_f32 v109, v109
    v_mfma_f32_32x32x16_bf16 v[124:139], v[48:51], v[204:207], v[140:155]
    v_exp_f32 v110, v110
    v_cvt_pk_bf16_f32 v192, v172, v173
    v_exp_f32 v111, v111
    v_cvt_pk_bf16_f32 v193, v174, v175
    v_exp_f32 v112, v112
    v_cvt_pk_bf16_f32 v194, v176, v177
    v_exp_f32 v113, v113
    v_cvt_pk_bf16_f32 v195, v178, v179
    v_exp_f32 v114, v114
    v_and_b32 v192, v192, v8
    v_exp_f32 v115, v115
    v_and_b32 v193, v193, v8
    v_cvt_pk_bf16_f32 v196, v108, v109
    v_cvt_pk_bf16_f32 v197, v110, v111
    v_cvt_pk_bf16_f32 v198, v112, v113
    v_cvt_pk_bf16_f32 v199, v114, v115
    v_exp_f32 v116, v116
    s_nop 0
    v_mfma_f32_32x32x16_bf16 v[156:171], v[96:99], v[196:199], v[156:171]
    v_exp_f32 v117, v117
    v_and_b32 v194, v194, v8
    v_exp_f32 v118, v118
    v_and_b32 v195, v195, v8
    v_exp_f32 v119, v119
    v_mov_b32 v208, v184
    v_exp_f32 v120, v120
    v_mov_b32 v209, v185
    v_exp_f32 v121, v121
    v_mov_b32 v210, v186
    v_exp_f32 v122, v122
    v_mov_b32 v211, v187
    v_exp_f32 v123, v123
    v_mov_b32 v140, v19
    v_cvt_pk_bf16_f32 v200, v116, v117
    v_cvt_pk_bf16_f32 v201, v118, v119
    v_cvt_pk_bf16_f32 v202, v120, v121
    v_cvt_pk_bf16_f32 v203, v122, v123
    v_exp_f32 v124, v124
    s_nop 0
    v_mfma_f32_32x32x16_bf16 v[156:171], v[100:103], v[200:203], v[156:171]
    v_exp_f32 v125, v125
    v_mov_b32 v141, v19
    v_exp_f32 v126, v126
    v_mov_b32 v142, v19
    v_exp_f32 v127, v127
    v_mov_b32 v143, v19
    v_cvt_pk_bf16_f32 v196, v124, v125
    v_cvt_pk_bf16_f32 v197, v126, v127
    v_mov_b32 v198, 0
    v_mov_b32 v199, 0
    s_nop 1
    v_mfma_f32_32x32x16_bf16 v[156:171], v[104:107], v[196:199], v[156:171]
    v_mov_b32 v144, v19
    v_mov_b32 v145, v19
    v_mov_b32 v146, v19
    v_mov_b32 v147, v19
    v_mov_b32 v148, v19
    v_mov_b32 v149, v19
    v_mov_b32 v150, v19
    v_mov_b32 v151, v19
    v_mov_b32 v152, v19
    v_mov_b32 v153, v19
    v_mov_b32 v154, v19
    v_mov_b32 v155, v19
    s_nop 1
    v_mfma_f32_32x32x16_bf16 v[108:123], v[36:39], v[192:195], v[140:155]
    v_mfma_f32_32x32x16_bf16 v[124:139], v[40:43], v[192:195], v[140:155]
    v_mov_b32 v216, 0x21800000
    v_cmp_nle_f32 vcc, v216, v164
    s_cbranch_vccnz L_fb_9
    v_rcp_f32 v216, v164
    v_cndmask_b32_e64 v212, v156, v160, s[38:39]
    v_cndmask_b32_e64 v213, v157, v161, s[38:39]
    v_cndmask_b32_e64 v214, v158, v162, s[38:39]
    v_cndmask_b32_e64 v215, v159, v163, s[38:39]
    v_mov_b32 v217, 6016
    v_mov_b32 v218, 0xb10
    v_cndmask_b32_e64 v217, v217, v218, s[38:39]
    v_add_u32 v217, v5, v217
    v_fma_f32 v212, v212, v216, v244
    v_fma_f32 v213, v213, v216, v245
    v_fma_f32 v214, v214, v216, v246
    v_fma_f32 v215, v215, v216, v247
    v_cvt_pk_bf16_f32 v212, v212, v213
    v_cvt_pk_bf16_f32 v213, v214, v215
    v_pk_max_i16 v212, v212, 0
    v_pk_max_i16 v213, v213, 0
    buffer_store_dwordx2 v[212:213], v217, s[8:11], s28 offen offset:0
L_after_9:
L_p2_10:
    v_exp_f32 v108, v108
    v_exp_f32 v109, v109
    v_exp_f32 v110, v110
    v_exp_f32 v111, v111
    v_exp_f32 v112, v112
    v_exp_f32 v113, v113
    v_exp_f32 v114, v114
    v_exp_f32 v115, v115
    v_cvt_pk_bf16_f32 v196, v108, v109
    v_cvt_pk_bf16_f32 v197, v110, v111
    v_cvt_pk_bf16_f32 v198, v112, v113
    v_cvt_pk_bf16_f32 v199, v114, v115
    v_exp_f32 v116, v116
    s_nop 0
    v_mfma_f32_32x32x16_bf16 v[156:171], v[80:83], v[196:199], 0
    v_exp_f32 v117, v117
    v_exp_f32 v118, v118
    v_exp_f32 v119, v119
    v_exp_f32 v120, v120
    v_exp_f32 v121, v121
    v_exp_f32 v122, v122
    v_exp_f32 v123, v123
    v_cvt_pk_bf16_f32 v200, v116, v117
    v_cvt_pk_bf16_f32 v201, v118, v119
    v_cvt_pk_bf16_f32 v202, v120, v121
    v_cvt_pk_bf16_f32 v203, v122, v123
    v_exp_f32 v124, v124
    s_nop 0
    v_mfma_f32_32x32x16_bf16 v[156:171], v[84:87], v[200:203], v[156:171]
    v_exp_f32 v125, v125
    v_mfma_f32_32x32x16_bf16 v[108:123], v[44:47], v[192:195], v[140:155]
    v_exp_f32 v126, v126
    s_waitcnt vmcnt(1)
    v_exp_f32 v127, v127
    v_mfma_f32_32x32x16_bf16 v[172:187], v[12:15], v[188:191], 0
    v_exp_f32 v128, v128
    s_add_u32 s46, s28, 5888
    v_exp_f32 v129, v129
    buffer_load_dwordx4 v[188:191], v3, s[4:7], s46 offen
    v_exp_f32 v130, v130
    v_exp_f32 v131, v131
    v_cvt_pk_bf16_f32 v196, v124, v125
    v_cvt_pk_bf16_f32 v197, v126, v127
    v_cvt_pk_bf16_f32 v198, v128, v129
    v_cvt_pk_bf16_f32 v199, v130, v131
    v_exp_f32 v132, v132
    s_nop 0
    v_mfma_f32_32x32x16_bf16 v[156:171], v[88:91], v[196:199], v[156:171]
    v_exp_f32 v133, v133
    v_exp_f32 v134, v134
    v_exp_f32 v135, v135
    v_exp_f32 v136, v136
    v_exp_f32 v137, v137
    v_exp_f32 v138, v138
    v_exp_f32 v139, v139
    v_cvt_pk_bf16_f32 v200, v132, v133
    v_cvt_pk_bf16_f32 v201, v134, v135
    v_cvt_pk_bf16_f32 v202, v136, v137
    v_cvt_pk_bf16_f32 v203, v138, v139
    v_exp_f32 v108, v108
    s_nop 0
    v_mfma_f32_32x32x16_bf16 v[156:171], v[92:95], v[200:203], v[156:171]
    v_exp_f32 v109, v109
    v_mfma_f32_32x32x16_bf16 v[124:139], v[48:51], v[192:195], v[140:155]
    v_exp_f32 v110, v110
    v_cvt_pk_bf16_f32 v204, v172, v173
    v_exp_f32 v111, v111
    v_cvt_pk_bf16_f32 v205, v174, v175
    v_exp_f32 v112, v112
    v_cvt_pk_bf16_f32 v206, v176, v177
    v_exp_f32 v113, v113
    v_cvt_pk_bf16_f32 v207, v178, v179
    v_exp_f32 v114, v114
    v_and_b32 v204, v204, v8
    v_exp_f32 v115, v115
    v_and_b32 v205, v205, v8
    v_cvt_pk_bf16_f32 v196, v108, v109
    v_cvt_pk_bf16_f32 v197, v110, v111
    v_cvt_pk_bf16_f32 v198, v112, v113
    v_cvt_pk_bf16_f32 v199, v114, v115
    v_exp_f32 v116, v116
    s_nop 0
    v_mfma_f32_32x32x16_bf16 v[156:171], v[96:99], v[196:199], v[156:171]
    v_exp_f32 v117, v117
    v_and_b32 v206, v206, v8
    v_exp_f32 v118, v118
    v_and_b32 v207, v207, v8
    v_exp_f32 v119, v119
    v_mov_b32 v244, v184
    v_exp_f32 v120, v120
    v_mov_b32 v245, v185
    v_exp_f32 v121, v121
    v_mov_b32 v246, v186
    v_exp_f32 v122, v122
    v_mov_b32 v247, v187
    v_exp_f32 v123, v123
    v_cvt_pk_bf16_f32 v200, v116, v117
    v_cvt_pk_bf16_f32 v201, v118, v119
    v_cvt_pk_bf16_f32 v202, v120, v121
    v_cvt_pk_bf16_f32 v203, v122, v123
    v_exp_f32 v124, v124
    s_nop 0
    v_mfma_f32_32x32x16_bf16 v[156:171], v[100:103], v[200:203], v[156:171]
    v_exp_f32 v125, v125
    v_exp_f32 v126, v126
    v_exp_f32 v127, v127
    v_cvt_pk_bf16_f32 v196, v124, v125
    v_cvt_pk_bf16_f32 v197, v126, v127
    v_mov_b32 v198, 0
    v_mov_b32 v199, 0
    s_nop 1
    v_mfma_f32_32x32x16_bf16 v[156:171], v[104:107], v[196:199], v[156:171]
    v_mfma_f32_32x32x16_bf16 v[108:123], v[36:39], v[204:207], v[140:155]
    v_mfma_f32_32x32x16_bf16 v[124:139], v[40:43], v[204:207], v[140:155]
    v_mov_b32 v216, 0x21800000
    s_nop 8
    v_cmp_nle_f32 vcc, v216, v164
    s_cbranch_vccnz L_fb_10
    v_rcp_f32 v216, v164
    s_add_u32 s47, s28, 3840
    v_fma_f32 v212, v160, v216, v208
    v_fma_f32 v213, v161, v216, v209
    v_fma_f32 v214, v162, v216, v210
    v_fma_f32 v215, v163, v216, v211
    v_cvt_pk_bf16_f32 v212, v212, v213
    v_cvt_pk_bf16_f32 v213, v214, v215
    v_pk_max_i16 v212, v212, 0
    v_pk_max_i16 v213, v213, 0
    buffer_store_dwordx2 v[212:213], v5, s[8:11], s47 offen offset:16
L_after_10:
L_p2_11:
    v_exp_f32 v108, v108
    v_exp_f32 v109, v109
    v_exp_f32 v110, v110
    v_exp_f32 v111, v111
    v_exp_f32 v112, v112
    v_exp_f32 v113, v113
    v_exp_f32 v114, v114
    v_exp_f32 v115, v115
    v_cvt_pk_bf16_f32 v196, v108, v109
    v_cvt_pk_bf16_f32 v197, v110, v111
    v_cvt_pk_bf16_f32 v198, v112, v113
    v_cvt_pk_bf16_f32 v199, v114, v115
    v_exp_f32 v116, v116
    s_nop 0
    v_mfma_f32_32x32x16_bf16 v[156:171], v[80:83], v[196:199], 0
    v_exp_f32 v117, v117
    v_exp_f32 v118, v118
    v_exp_f32 v119, v119
    v_exp_f32 v120, v120
    v_exp_f32 v121, v121
    v_exp_f32 v122, v122
    v_exp_f32 v123, v123
    v_cvt_pk_bf16_f32 v200, v116, v117
    v_cvt_pk_bf16_f32 v201, v118, v119
    v_cvt_pk_bf16_f32 v202, v120, v121
    v_cvt_pk_bf16_f32 v203, v122, v123
    v_exp_f32 v124, v124
    s_nop 0
    v_mfma_f32_32x32x16_bf16 v[156:171], v[84:87], v[200:203], v[156:171]
    v_exp_f32 v125, v125
    v_mfma_f32_32x32x16_bf16 v[108:123], v[44:47], v[204:207], v[140:155]
    v_exp_f32 v126, v126
    s_waitcnt vmcnt(1)
    v_exp_f32 v127, v127
    v_mfma_f32_32x32x16_bf16 v[172:187], v[12:15], v[188:191], 0
    v_exp_f32 v128, v128
    v_exp_f32 v129, v129
    v_exp_f32 v130, v130
    v_exp_f32 v131, v131
    v_cvt_pk_bf16_f32 v196, v124, v125
    v_cvt_pk_bf16_f32 v197, v126, v127
    v_cvt_pk_bf16_f32 v198, v128, v129
    v_cvt_pk_bf16_f32 v199, v130, v131
    v_exp_f32 v132, v132
    s_nop 0
    v_mfma_f32_32x32x16_bf16 v[156:171], v[88:91], v[196:199], v[156:171]
    v_exp_f32 v133, v133
    v_exp_f32 v134, v134
    v_exp_f32 v135, v135
    v_exp_f32 v136, v136
    v_exp_f32 v137, v137
    v_exp_f32 v138, v138
    v_exp_f32 v139, v139
    v_cvt_pk_bf16_f32 v200, v132, v133
    v_cvt_pk_bf16_f32 v201, v134, v135
    v_cvt_pk_bf16_f32 v202, v136, v137
    v_cvt_pk_bf16_f32 v203, v138, v139
    v_exp_f32 v108, v108
    s_nop 0
    v_mfma_f32_32x32x16_bf16 v[156:171], v[92:95], v[200:203], v[156:171]
    v_exp_f32 v109, v109
    v_mfma_f32_32x32x16_bf16 v[124:139], v[48:51], v[204:207], v[140:155]
    v_exp_f32 v110, v110
    v_cmp_le_u32 s[38:39], 16, v1
    v_exp_f32 v111, v111
    v_cvt_pk_bf16_f32 v192, v172, v173
    v_exp_f32 v112, v112
    v_cvt_pk_bf16_f32 v193, v174, v175
    v_exp_f32 v113, v113
    v_cvt_pk_bf16_f32 v194, v176, v177
    v_exp_f32 v114, v114
    v_cvt_pk_bf16_f32 v195, v178, v179
    v_exp_f32 v115, v115
    v_cndmask_b32_e64 v217, v8, v7, s[38:39]
    v_cvt_pk_bf16_f32 v196, v108, v109
    v_cvt_pk_bf16_f32 v197, v110, v111
    v_cvt_pk_bf16_f32 v198, v112, v113
    v_cvt_pk_bf16_f32 v199, v114, v115
    v_exp_f32 v116, v116
    s_nop 0
    v_mfma_f32_32x32x16_bf16 v[156:171], v[96:99], v[196:199], v[156:171]
    v_exp_f32 v117, v117
    v_and_b32 v192, v192, v217
    v_exp_f32 v118, v118
    v_and_b32 v193, v193, v217
    v_exp_f32 v119, v119
    v_and_b32 v194, v194, v217
    v_exp_f32 v120, v120
    v_and_b32 v195, v195, v217
    v_exp_f32 v121, v121
    v_cndmask_b32_e64 v208, v184, v180, s[38:39]
    v_exp_f32 v122, v122
    v_cndmask_b32_e64 v209, v185, v181, s[38:39]
    v_exp_f32 v123, v123
    v_cndmask_b32_e64 v210, v186, v182, s[38:39]
    v_cvt_pk_bf16_f32 v200, v116, v117
    v_cvt_pk_bf16_f32 v201, v118, v119
    v_cvt_pk_bf16_f32 v202, v120, v121
    v_cvt_pk_bf16_f32 v203, v122, v123
    v_exp_f32 v124, v124
    s_nop 0
    v_mfma_f32_32x32x16_bf16 v[156:171], v[100:103], v[200:203], v[156:171]
    v_exp_f32 v125, v125
    v_cndmask_b32_e64 v211, v187, v183, s[38:39]
    v_exp_f32 v126, v126
    v_cndmask_b32_e64 v216, v19, v19, s[38:39]
    v_exp_f32 v127, v127
    v_mov_b32 v140, v216
    v_cvt_pk_bf16_f32 v196, v124, v125
    v_cvt_pk_bf16_f32 v197, v126, v127
    v_mov_b32 v198, 0
    v_mov_b32 v199, 0
    s_nop 1
    v_mfma_f32_32x32x16_bf16 v[156:171], v[104:107], v[196:199], v[156:171]
    v_mov_b32 v141, v216
    v_mov_b32 v142, v216
    v_mov_b32 v143, v216
    v_mov_b32 v144, v216
    v_mov_b32 v145, v216
    v_mov_b32 v146, v216
    v_mov_b32 v147, v216
    v_mov_b32 v148, v216
    v_mov_b32 v149, v216
    v_mov_b32 v150, v216
    v_mov_b32 v151, v216
    v_mov_b32 v152, v216
    v_mov_b32 v153, v216
    v_mov_b32 v154, v216
    v_mov_b32 v155, v216
    s_nop 1
    v_mfma_f32_32x32x16_bf16 v[108:123], v[36:39], v[192:195], v[140:155]
    v_mfma_f32_32x32x16_bf16 v[124:139], v[40:43], v[192:195], v[140:155]
    v_mov_b32 v216, 0x21800000
    v_cmp_nle_f32 vcc, v216, v164
    s_cbranch_vccnz L_fb_11
    v_rcp_f32 v216, v164
    s_add_u32 s47, s28, 4864
    v_fma_f32 v212, v160, v216, v244
    v_fma_f32 v213, v161, v216, v245
    v_fma_f32 v214, v162, v216, v246
    v_fma_f32 v215, v163, v216, v247
    v_cvt_pk_bf16_f32 v212, v212, v213
    v_cvt_pk_bf16_f32 v213, v214, v215
    v_pk_max_i16 v212, v212, 0
    v_pk_max_i16 v213, v213, 0
    buffer_store_dwordx2 v[212:213], v5, s[8:11], s47 offen offset:16
L_after_11:
L_p2_12:
    v_exp_f32 v108, v108
    v_exp_f32 v109, v109
    v_exp_f32 v110, v110
    v_exp_f32 v111, v111
    v_exp_f32 v112, v112
    v_exp_f32 v113, v113
    v_exp_f32 v114, v114
    v_exp_f32 v115, v115
    v_cvt_pk_bf16_f32 v196, v108, v109
    v_cvt_pk_bf16_f32 v197, v110, v111
    v_cvt_pk_bf16_f32 v198, v112, v113
    v_cvt_pk_bf16_f32 v199, v114, v115
    v_exp_f32 v116, v116
    s_nop 0
    v_mfma_f32_32x32x16_bf16 v[156:171], v[80:83], v[196:199], 0
    v_exp_f32 v117, v117
    v_exp_f32 v118, v118
    v_exp_f32 v119, v119
    v_exp_f32 v120, v120
    v_exp_f32 v121, v121
    v_exp_f32 v122, v122
    v_exp_f32 v123, v123
    v_cvt_pk_bf16_f32 v200, v116, v117
    v_cvt_pk_bf16_f32 v201, v118, v119
    v_cvt_pk_bf16_f32 v202, v120, v121
    v_cvt_pk_bf16_f32 v203, v122, v123
    v_exp_f32 v124, v124
    s_nop 0
    v_mfma_f32_32x32x16_bf16 v[156:171], v[84:87], v[200:203], v[156:171]
    v_exp_f32 v125, v125
    v_mfma_f32_32x32x16_bf16 v[108:123], v[44:47], v[192:195], v[140:155]
    v_exp_f32 v126, v126
    v_exp_f32 v127, v127
    v_exp_f32 v128, v128
    v_exp_f32 v129, v129
    v_exp_f32 v130, v130
    v_exp_f32 v131, v131
    v_cvt_pk_bf16_f32 v196, v124, v125
    v_cvt_pk_bf16_f32 v197, v126, v127
    v_cvt_pk_bf16_f32 v198, v128, v129
    v_cvt_pk_bf16_f32 v199, v130, v131
    v_exp_f32 v132, v132
    s_nop 0
    v_mfma_f32_32x32x16_bf16 v[156:171], v[88:91], v[196:199], v[156:171]
    v_exp_f32 v133, v133
    v_exp_f32 v134, v134
    v_exp_f32 v135, v135
    v_exp_f32 v136, v136
    v_exp_f32 v137, v137
    v_exp_f32 v138, v138
    v_exp_f32 v139, v139
    v_cvt_pk_bf16_f32 v200, v132, v133
    v_cvt_pk_bf16_f32 v201, v134, v135
    v_cvt_pk_bf16_f32 v202, v136, v137
    v_cvt_pk_bf16_f32 v203, v138, v139
    v_exp_f32 v108, v108
    s_nop 0
    v_mfma_f32_32x32x16_bf16 v[156:171], v[92:95], v[200:203], v[156:171]
    v_exp_f32 v109, v109
    v_mfma_f32_32x32x16_bf16 v[124:139], v[48:51], v[192:195], v[140:155]
    v_exp_f32 v110, v110
    v_exp_f32 v111, v111
    v_exp_f32 v112, v112
    v_exp_f32 v113, v113
    v_exp_f32 v114, v114
    v_exp_f32 v115, v115
    v_cvt_pk_bf16_f32 v196, v108, v109
    v_cvt_pk_bf16_f32 v197, v110, v111
    v_cvt_pk_bf16_f32 v198, v112, v113
    v_cvt_pk_bf16_f32 v199, v114, v115
    v_exp_f32 v116, v116
    s_nop 0
    v_mfma_f32_32x32x16_bf16 v[156:171], v[96:99], v[196:199], v[156:171]
    v_exp_f32 v117, v117
    v_exp_f32 v118, v118
    v_exp_f32 v119, v119
    v_exp_f32 v120, v120
    v_exp_f32 v121, v121
    v_exp_f32 v122, v122
    v_exp_f32 v123, v123
    v_cvt_pk_bf16_f32 v200, v116, v117
    v_cvt_pk_bf16_f32 v201, v118, v119
    v_cvt_pk_bf16_f32 v202, v120, v121
    v_cvt_pk_bf16_f32 v203, v122, v123
    v_exp_f32 v124, v124
    s_nop 0
    v_mfma_f32_32x32x16_bf16 v[156:171], v[100:103], v[200:203], v[156:171]
    v_exp_f32 v125, v125
    v_exp_f32 v126, v126
    v_exp_f32 v127, v127
    v_cvt_pk_bf16_f32 v196, v124, v125
    v_cvt_pk_bf16_f32 v197, v126, v127
    v_mov_b32 v198, 0
    v_mov_b32 v199, 0
    s_nop 1
    v_mfma_f32_32x32x16_bf16 v[156:171], v[104:107], v[196:199], v[156:171]
    v_mov_b32 v216, 0x21800000
    s_nop 10
    v_cmp_nle_f32 vcc, v216, v164
    s_cbranch_vccnz L_fb_12
    v_rcp_f32 v216, v164
    v_cndmask_b32_e64 v212, v160, v156, s[38:39]
    v_cndmask_b32_e64 v213, v161, v157, s[38:39]
    v_cndmask_b32_e64 v214, v162, v158, s[38:39]
    v_cndmask_b32_e64 v215, v163, v159, s[38:39]
    v_mov_b32 v217, 5888
    v_mov_b32 v218, 0x4001700
    v_cndmask_b32_e64 v217, v217, v218, s[38:39]
    v_add_u32 v217, v5, v217
    v_fma_f32 v212, v212, v216, v208
    v_fma_f32 v213, v213, v216, v209
    v_fma_f32 v214, v214, v216, v210
    v_fma_f32 v215, v215, v216, v211
    v_cvt_pk_bf16_f32 v212, v212, v213
    v_cvt_pk_bf16_f32 v213, v214, v215
    v_pk_max_i16 v212, v212, 0
    v_pk_max_i16 v213, v213, 0
    buffer_store_dwordx2 v[212:213], v217, s[8:11], s28 offen offset:16
L_after_12:
L_end:
    s_endpgm
L_fb_0:
    s_nop 15
    s_waitcnt vmcnt(0)
    s_add_u32 s46, s28, 0
    buffer_load_dwordx4 v[188:191], v3, s[4:7], s46 offen
    s_waitcnt vmcnt(0)
    v_mfma_f32_32x32x16_bf16 v[172:187], v[12:15], v[188:191], 0
    s_nop 11
    v_cvt_pk_bf16_f32 v192, v172, v173
    v_cvt_pk_bf16_f32 v193, v174, v175
    v_cvt_pk_bf16_f32 v194, v176, v177
    v_cvt_pk_bf16_f32 v195, v178, v179
    v_and_b32 v192, v192, v7
    v_and_b32 v193, v193, v7
    v_and_b32 v194, v194, v7
    v_and_b32 v195, v195, v7
    v_mov_b32 v208, v180
    v_mov_b32 v209, v181
    v_mov_b32 v210, v182
    v_mov_b32 v211, v183
    v_mfma_f32_32x32x16_bf16 v[108:123], v[20:23], v[192:195], 0
    v_mfma_f32_32x32x16_bf16 v[124:139], v[24:27], v[192:195], 0
    v_mfma_f32_32x32x16_bf16 v[140:155], v[28:31], v[192:195], 0
    v_mfma_f32_32x32x16_bf16 v[156:171], v[32:35], v[192:195], 0
    s_nop 8
    v_max3_f32 v214, v108, v109, v110
    v_max3_f32 v215, v111, v112, v113
    v_max3_f32 v214, v214, v114, v115
    v_max3_f32 v215, v215, v116, v117
    v_max3_f32 v214, v214, v118, v119
    v_max3_f32 v215, v215, v120, v121
    v_max3_f32 v214, v214, v122, v123
    v_max3_f32 v215, v215, v124, v125
    v_max3_f32 v214, v214, v126, v127
    v_max3_f32 v215, v215, v128, v129
    v_max3_f32 v214, v214, v130, v131
    v_max3_f32 v215, v215, v132, v133
    v_max3_f32 v214, v214, v134, v135
    v_max3_f32 v215, v215, v136, v137
    v_max3_f32 v214, v214, v138, v139
    v_max3_f32 v215, v215, v140, v141
    v_max3_f32 v214, v214, v142, v143
    v_max3_f32 v215, v215, v144, v145
    v_max3_f32 v214, v214, v146, v147
    v_max3_f32 v215, v215, v148, v149
    v_max3_f32 v214, v214, v150, v151
    v_max3_f32 v215, v215, v152, v153
    v_max3_f32 v214, v214, v154, v155
    v_max3_f32 v215, v215, v156, v157
    v_max3_f32 v214, v214, v158, v159
    v_max_f32 v214, v214, v215
    v_mov_b32 v215, v214
    s_nop 1
    v_permlane32_swap_b32 v214, v215
    v_max_f32 v214, v214, v215
    v_mul_f32 v140, -1.0, v214
    v_mul_f32 v141, -1.0, v214
    v_mul_f32 v142, -1.0, v214
    v_mul_f32 v143, -1.0, v214
    v_mul_f32 v144, -1.0, v214
    v_mul_f32 v145, -1.0, v214
    v_mul_f32 v146, -1.0, v214
    v_mul_f32 v147, -1.0, v214
    v_mul_f32 v148, -1.0, v214
    v_mul_f32 v149, -1.0, v214
    v_mul_f32 v150, -1.0, v214
    v_mul_f32 v151, -1.0, v214
    v_mul_f32 v152, -1.0, v214
    v_mul_f32 v153, -1.0, v214
    v_mul_f32 v154, -1.0, v214
    v_mul_f32 v155, -1.0, v214
    s_nop 1
    v_mfma_f32_32x32x16_bf16 v[108:123], v[20:23], v[192:195], v[140:155]
    v_mfma_f32_32x32x16_bf16 v[124:139], v[24:27], v[192:195], v[140:155]
    s_nop 10
    v_exp_f32 v108, v108
    v_exp_f32 v109, v109
    v_exp_f32 v110, v110
    v_exp_f32 v111, v111
    v_exp_f32 v112, v112
    v_exp_f32 v113, v113
    v_exp_f32 v114, v114
    v_exp_f32 v115, v115
    v_cvt_pk_bf16_f32 v196, v108, v109
    v_cvt_pk_bf16_f32 v197, v110, v111
    v_cvt_pk_bf16_f32 v198, v112, v113
    v_cvt_pk_bf16_f32 v199, v114, v115
    s_nop 1
    v_mfma_f32_32x32x16_bf16 v[156:171], v[52:55], v[196:199], 0
    v_exp_f32 v116, v116
    v_exp_f32 v117, v117
    v_exp_f32 v118, v118
    v_exp_f32 v119, v119
    v_exp_f32 v120, v120
    v_exp_f32 v121, v121
    v_exp_f32 v122, v122
    v_exp_f32 v123, v123
    v_cvt_pk_bf16_f32 v200, v116, v117
    v_cvt_pk_bf16_f32 v201, v118, v119
    v_cvt_pk_bf16_f32 v202, v120, v121
    v_cvt_pk_bf16_f32 v203, v122, v123
    s_nop 1
    v_mfma_f32_32x32x16_bf16 v[156:171], v[56:59], v[200:203], v[156:171]
    v_mfma_f32_32x32x16_bf16 v[108:123], v[28:31], v[192:195], v[140:155]
    v_exp_f32 v124, v124
    v_exp_f32 v125, v125
    v_exp_f32 v126, v126
    v_exp_f32 v127, v127
    v_exp_f32 v128, v128
    v_exp_f32 v129, v129
    v_exp_f32 v130, v130
    v_exp_f32 v131, v131
    v_cvt_pk_bf16_f32 v196, v124, v125
    v_cvt_pk_bf16_f32 v197, v126, v127
    v_cvt_pk_bf16_f32 v198, v128, v129
    v_cvt_pk_bf16_f32 v199, v130, v131
    s_nop 1
    v_mfma_f32_32x32x16_bf16 v[156:171], v[60:63], v[196:199], v[156:171]
    v_exp_f32 v132, v132
    v_exp_f32 v133, v133
    v_exp_f32 v134, v134
    v_exp_f32 v135, v135
    v_exp_f32 v136, v136
    v_exp_f32 v137, v137
    v_exp_f32 v138, v138
    v_exp_f32 v139, v139
    v_cvt_pk_bf16_f32 v200, v132, v133
    v_cvt_pk_bf16_f32 v201, v134, v135
    v_cvt_pk_bf16_f32 v202, v136, v137
    v_cvt_pk_bf16_f32 v203, v138, v139
    s_nop 1
    v_mfma_f32_32x32x16_bf16 v[156:171], v[64:67], v[200:203], v[156:171]
    v_mfma_f32_32x32x16_bf16 v[124:139], v[32:35], v[192:195], v[140:155]
    v_exp_f32 v108, v108
    v_exp_f32 v109, v109
    v_exp_f32 v110, v110
    v_exp_f32 v111, v111
    v_exp_f32 v112, v112
    v_exp_f32 v113, v113
    v_exp_f32 v114, v114
    v_exp_f32 v115, v115
    v_cvt_pk_bf16_f32 v196, v108, v109
    v_cvt_pk_bf16_f32 v197, v110, v111
    v_cvt_pk_bf16_f32 v198, v112, v113
    v_cvt_pk_bf16_f32 v199, v114, v115
    s_nop 1
    v_mfma_f32_32x32x16_bf16 v[156:171], v[68:71], v[196:199], v[156:171]
    v_exp_f32 v116, v116
    v_exp_f32 v117, v117
    v_exp_f32 v118, v118
    v_exp_f32 v119, v119
    v_exp_f32 v120, v120
    v_exp_f32 v121, v121
    v_exp_f32 v122, v122
    v_exp_f32 v123, v123
    v_cvt_pk_bf16_f32 v200, v116, v117
    v_cvt_pk_bf16_f32 v201, v118, v119
    v_cvt_pk_bf16_f32 v202, v120, v121
    v_cvt_pk_bf16_f32 v203, v122, v123
    s_nop 1
    v_mfma_f32_32x32x16_bf16 v[156:171], v[72:75], v[200:203], v[156:171]
    v_exp_f32 v124, v124
    v_exp_f32 v125, v125
    v_exp_f32 v126, v126
    v_exp_f32 v127, v127
    v_cvt_pk_bf16_f32 v196, v124, v125
    v_cvt_pk_bf16_f32 v197, v126, v127
    v_mov_b32 v198, 0
    v_mov_b32 v199, 0
    s_nop 1
    v_mfma_f32_32x32x16_bf16 v[156:171], v[76:79], v[196:199], v[156:171]
    s_nop 11
    v_rcp_f32 v216, v164
    s_add_u32 s47, s28, 0
    v_fma_f32 v212, v156, v216, v208
    v_fma_f32 v213, v157, v216, v209
    v_fma_f32 v214, v158, v216, v210
    v_fma_f32 v215, v159, v216, v211
    v_cvt_pk_bf16_f32 v212, v212, v213
    v_cvt_pk_bf16_f32 v213, v214, v215
    v_pk_max_i16 v212, v212, 0
    v_pk_max_i16 v213, v213, 0
    buffer_store_dwordx2 v[212:213], v5, s[8:11], s47 offen offset:0
    s_add_u32 s46, s28, 1024
    buffer_load_dwordx4 v[188:191], v3, s[4:7], s46 offen
    s_waitcnt vmcnt(0)
    v_mfma_f32_32x32x16_bf16 v[172:187], v[12:15], v[188:191], 0
    v_mov_b32 v140, v16
    v_mov_b32 v141, v16
    v_mov_b32 v142, v16
    v_mov_b32 v143, v16
    v_mov_b32 v144, v16
    v_mov_b32 v145, v16
    v_mov_b32 v146, v16
    v_mov_b32 v147, v16
    v_mov_b32 v148, v16
    v_mov_b32 v149, v16
    v_mov_b32 v150, v16
    v_mov_b32 v151, v16
    v_mov_b32 v152, v16
    v_mov_b32 v153, v16
    v_mov_b32 v154, v16
    v_mov_b32 v155, v16
    v_cvt_pk_bf16_f32 v204, v172, v173
    v_cvt_pk_bf16_f32 v205, v174, v175
    v_cvt_pk_bf16_f32 v206, v176, v177
    v_cvt_pk_bf16_f32 v207, v178, v179
    v_and_b32 v204, v204, v7
    v_and_b32 v205, v205, v7
    v_and_b32 v206, v206, v7
    v_and_b32 v207, v207, v7
    v_mov_b32 v244, v180
    v_mov_b32 v245, v181
    v_mov_b32 v246, v182
    v_mov_b32 v247, v183
    v_mfma_f32_32x32x16_bf16 v[108:123], v[20:23], v[204:207], v[140:155]
    v_mfma_f32_32x32x16_bf16 v[124:139], v[24:27], v[204:207], v[140:155]
    s_add_u32 s46, s28, 2048
    buffer_load_dwordx4 v[188:191], v3, s[4:7], s46 offen
    s_waitcnt vmcnt(0)
    s_nop 15
    s_branch L_after_0
L_fb_1:
    s_nop 15
    s_waitcnt vmcnt(0)
    s_add_u32 s46, s28, 1024
    buffer_load_dwordx4 v[188:191], v3, s[4:7], s46 offen
    s_waitcnt vmcnt(0)
    v_mfma_f32_32x32x16_bf16 v[172:187], v[12:15], v[188:191], 0
    s_nop 11
    v_cvt_pk_bf16_f32 v204, v172, v173
    v_cvt_pk_bf16_f32 v205, v174, v175
    v_cvt_pk_bf16_f32 v206, v176, v177
    v_cvt_pk_bf16_f32 v207, v178, v179
    v_and_b32 v204, v204, v7
    v_and_b32 v205, v205, v7
    v_and_b32 v206, v206, v7
    v_and_b32 v207, v207, v7
    v_mov_b32 v244, v180
    v_mov_b32 v245, v181
    v_mov_b32 v246, v182
    v_mov_b32 v247, v183
    v_mfma_f32_32x32x16_bf16 v[108:123], v[20:23], v[204:207], 0
    v_mfma_f32_32x32x16_bf16 v[124:139], v[24:27], v[204:207], 0
    v_mfma_f32_32x32x16_bf16 v[140:155], v[28:31], v[204:207], 0
    v_mfma_f32_32x32x16_bf16 v[156:171], v[32:35], v[204:207], 0
    s_nop 8
    v_max3_f32 v214, v108, v109, v110
    v_max3_f32 v215, v111, v112, v113
    v_max3_f32 v214, v214, v114, v115
    v_max3_f32 v215, v215, v116, v117
    v_max3_f32 v214, v214, v118, v119
    v_max3_f32 v215, v215, v120, v121
    v_max3_f32 v214, v214, v122, v123
    v_max3_f32 v215, v215, v124, v125
    v_max3_f32 v214, v214, v126, v127
    v_max3_f32 v215, v215, v128, v129
    v_max3_f32 v214, v214, v130, v131
    v_max3_f32 v215, v215, v132, v133
    v_max3_f32 v214, v214, v134, v135
    v_max3_f32 v215, v215, v136, v137
    v_max3_f32 v214, v214, v138, v139
    v_max3_f32 v215, v215, v140, v141
    v_max3_f32 v214, v214, v142, v143
    v_max3_f32 v215, v215, v144, v145
    v_max3_f32 v214, v214, v146, v147
    v_max3_f32 v215, v215, v148, v149
    v_max3_f32 v214, v214, v150, v151
    v_max3_f32 v215, v215, v152, v153
    v_max3_f32 v214, v214, v154, v155
    v_max3_f32 v215, v215, v156, v157
    v_max3_f32 v214, v214, v158, v159
    v_max_f32 v214, v214, v215
    v_mov_b32 v215, v214
    s_nop 1
    v_permlane32_swap_b32 v214, v215
    v_max_f32 v214, v214, v215
    v_mul_f32 v140, -1.0, v214
    v_mul_f32 v141, -1.0, v214
    v_mul_f32 v142, -1.0, v214
    v_mul_f32 v143, -1.0, v214
    v_mul_f32 v144, -1.0, v214
    v_mul_f32 v145, -1.0, v214
    v_mul_f32 v146, -1.0, v214
    v_mul_f32 v147, -1.0, v214
    v_mul_f32 v148, -1.0, v214
    v_mul_f32 v149, -1.0, v214
    v_mul_f32 v150, -1.0, v214
    v_mul_f32 v151, -1.0, v214
    v_mul_f32 v152, -1.0, v214
    v_mul_f32 v153, -1.0, v214
    v_mul_f32 v154, -1.0, v214
    v_mul_f32 v155, -1.0, v214
    s_nop 1
    v_mfma_f32_32x32x16_bf16 v[108:123], v[20:23], v[204:207], v[140:155]
    v_mfma_f32_32x32x16_bf16 v[124:139], v[24:27], v[204:207], v[140:155]
    s_nop 10
    v_exp_f32 v108, v108
    v_exp_f32 v109, v109
    v_exp_f32 v110, v110
    v_exp_f32 v111, v111
    v_exp_f32 v112, v112
    v_exp_f32 v113, v113
    v_exp_f32 v114, v114
    v_exp_f32 v115, v115
    v_cvt_pk_bf16_f32 v196, v108, v109
    v_cvt_pk_bf16_f32 v197, v110, v111
    v_cvt_pk_bf16_f32 v198, v112, v113
    v_cvt_pk_bf16_f32 v199, v114, v115
    s_nop 1
    v_mfma_f32_32x32x16_bf16 v[156:171], v[52:55], v[196:199], 0
    v_exp_f32 v116, v116
    v_exp_f32 v117, v117
    v_exp_f32 v118, v118
    v_exp_f32 v119, v119
    v_exp_f32 v120, v120
    v_exp_f32 v121, v121
    v_exp_f32 v122, v122
    v_exp_f32 v123, v123
    v_cvt_pk_bf16_f32 v200, v116, v117
    v_cvt_pk_bf16_f32 v201, v118, v119
    v_cvt_pk_bf16_f32 v202, v120, v121
    v_cvt_pk_bf16_f32 v203, v122, v123
    s_nop 1
    v_mfma_f32_32x32x16_bf16 v[156:171], v[56:59], v[200:203], v[156:171]
    v_mfma_f32_32x32x16_bf16 v[108:123], v[28:31], v[204:207], v[140:155]
    v_exp_f32 v124, v124
    v_exp_f32 v125, v125
    v_exp_f32 v126, v126
    v_exp_f32 v127, v127
    v_exp_f32 v128, v128
    v_exp_f32 v129, v129
    v_exp_f32 v130, v130
    v_exp_f32 v131, v131
    v_cvt_pk_bf16_f32 v196, v124, v125
    v_cvt_pk_bf16_f32 v197, v126, v127
    v_cvt_pk_bf16_f32 v198, v128, v129
    v_cvt_pk_bf16_f32 v199, v130, v131
    s_nop 1
    v_mfma_f32_32x32x16_bf16 v[156:171], v[60:63], v[196:199], v[156:171]
    v_exp_f32 v132, v132
    v_exp_f32 v133, v133
    v_exp_f32 v134, v134
    v_exp_f32 v135, v135
    v_exp_f32 v136, v136
    v_exp_f32 v137, v137
    v_exp_f32 v138, v138
    v_exp_f32 v139, v139
    v_cvt_pk_bf16_f32 v200, v132, v133
    v_cvt_pk_bf16_f32 v201, v134, v135
    v_cvt_pk_bf16_f32 v202, v136, v137
    v_cvt_pk_bf16_f32 v203, v138, v139
    s_nop 1
    v_mfma_f32_32x32x16_bf16 v[156:171], v[64:67], v[200:203], v[156:171]
    v_mfma_f32_32x32x16_bf16 v[124:139], v[32:35], v[204:207], v[140:155]
    v_exp_f32 v108, v108
    v_exp_f32 v109, v109
    v_exp_f32 v110, v110
    v_exp_f32 v111, v111
    v_exp_f32 v112, v112
    v_exp_f32 v113, v113
    v_exp_f32 v114, v114
    v_exp_f32 v115, v115
    v_cvt_pk_bf16_f32 v196, v108, v109
    v_cvt_pk_bf16_f32 v197, v110, v111
    v_cvt_pk_bf16_f32 v198, v112, v113
    v_cvt_pk_bf16_f32 v199, v114, v115
    s_nop 1
    v_mfma_f32_32x32x16_bf16 v[156:171], v[68:71], v[196:199], v[156:171]
    v_exp_f32 v116, v116
    v_exp_f32 v117, v117
    v_exp_f32 v118, v118
    v_exp_f32 v119, v119
    v_exp_f32 v120, v120
    v_exp_f32 v121, v121
    v_exp_f32 v122, v122
    v_exp_f32 v123, v123
    v_cvt_pk_bf16_f32 v200, v116, v117
    v_cvt_pk_bf16_f32 v201, v118, v119
    v_cvt_pk_bf16_f32 v202, v120, v121
    v_cvt_pk_bf16_f32 v203, v122, v123
    s_nop 1
    v_mfma_f32_32x32x16_bf16 v[156:171], v[72:75], v[200:203], v[156:171]
    v_exp_f32 v124, v124
    v_exp_f32 v125, v125
    v_exp_f32 v126, v126
    v_exp_f32 v127, v127
    v_cvt_pk_bf16_f32 v196, v124, v125
    v_cvt_pk_bf16_f32 v197, v126, v127
    v_mov_b32 v198, 0
    v_mov_b32 v199, 0
    s_nop 1
    v_mfma_f32_32x32x16_bf16 v[156:171], v[76:79], v[196:199], v[156:171]
    s_nop 11
    v_rcp_f32 v216, v164
    s_add_u32 s47, s28, 1024
    v_fma_f32 v212, v156, v216, v244
    v_fma_f32 v213, v157, v216, v245
    v_fma_f32 v214, v158, v216, v246
    v_fma_f32 v215, v159, v216, v247
    v_cvt_pk_bf16_f32 v212, v212, v213
    v_cvt_pk_bf16_f32 v213, v214, v215
    v_pk_max_i16 v212, v212, 0
    v_pk_max_i16 v213, v213, 0
    buffer_store_dwordx2 v[212:213], v5, s[8:11], s47 offen offset:0
    s_add_u32 s46, s28, 2048
    buffer_load_dwordx4 v[188:191], v3, s[4:7], s46 offen
    s_waitcnt vmcnt(0)
    v_mfma_f32_32x32x16_bf16 v[172:187], v[12:15], v[188:191], 0
    v_mov_b32 v140, v16
    v_mov_b32 v141, v16
    v_mov_b32 v142, v16
    v_mov_b32 v143, v16
    v_mov_b32 v144, v16
    v_mov_b32 v145, v16
    v_mov_b32 v146, v16
    v_mov_b32 v147, v16
    v_mov_b32 v148, v16
    v_mov_b32 v149, v16
    v_mov_b32 v150, v16
    v_mov_b32 v151, v16
    v_mov_b32 v152, v16
    v_mov_b32 v153, v16
    v_mov_b32 v154, v16
    v_mov_b32 v155, v16
    v_cvt_pk_bf16_f32 v192, v172, v173
    v_cvt_pk_bf16_f32 v193, v174, v175
    v_cvt_pk_bf16_f32 v194, v176, v177
    v_cvt_pk_bf16_f32 v195, v178, v179
    v_and_b32 v192, v192, v7
    v_and_b32 v193, v193, v7
    v_and_b32 v194, v194, v7
    v_and_b32 v195, v195, v7
    v_mov_b32 v208, v180
    v_mov_b32 v209, v181
    v_mov_b32 v210, v182
    v_mov_b32 v211, v183
    v_mfma_f32_32x32x16_bf16 v[108:123], v[20:23], v[192:195], v[140:155]
    v_mfma_f32_32x32x16_bf16 v[124:139], v[24:27], v[192:195], v[140:155]
    v_cmp_le_u32 s[40:41], 4, v1
    v_mov_b32 v212, 3072
    v_mov_b32 v213, -128
    v_cndmask_b32_e64 v212, v212, v213, s[40:41]
    v_add_u32 v212, v3, v212
    buffer_load_dwordx4 v[188:191], v212, s[4:7], s28 offen
    s_waitcnt vmcnt(0)
    s_nop 15
    s_branch L_after_1
L_fb_2:
    s_nop 15
    s_waitcnt vmcnt(0)
    s_add_u32 s46, s28, 2048
    buffer_load_dwordx4 v[188:191], v3, s[4:7], s46 offen
    s_waitcnt vmcnt(0)
    v_mfma_f32_32x32x16_bf16 v[172:187], v[12:15], v[188:191], 0
    s_nop 11
    v_cvt_pk_bf16_f32 v192, v172, v173
    v_cvt_pk_bf16_f32 v193, v174, v175
    v_cvt_pk_bf16_f32 v194, v176, v177
    v_cvt_pk_bf16_f32 v195, v178, v179
    v_and_b32 v192, v192, v7
    v_and_b32 v193, v193, v7
    v_and_b32 v194, v194, v7
    v_and_b32 v195, v195, v7
    v_mov_b32 v208, v180
    v_mov_b32 v209, v181
    v_mov_b32 v210, v182
    v_mov_b32 v211, v183
    v_mfma_f32_32x32x16_bf16 v[108:123], v[20:23], v[192:195], 0
    v_mfma_f32_32x32x16_bf16 v[124:139], v[24:27], v[192:195], 0
    v_mfma_f32_32x32x16_bf16 v[140:155], v[28:31], v[192:195], 0
    v_mfma_f32_32x32x16_bf16 v[156:171], v[32:35], v[192:195], 0
    s_nop 8
    v_max3_f32 v214, v108, v109, v110
    v_max3_f32 v215, v111, v112, v113
    v_max3_f32 v214, v214, v114, v115
    v_max3_f32 v215, v215, v116, v117
    v_max3_f32 v214, v214, v118, v119
    v_max3_f32 v215, v215, v120, v121
    v_max3_f32 v214, v214, v122, v123
    v_max3_f32 v215, v215, v124, v125
    v_max3_f32 v214, v214, v126, v127
    v_max3_f32 v215, v215, v128, v129
    v_max3_f32 v214, v214, v130, v131
    v_max3_f32 v215, v215, v132, v133
    v_max3_f32 v214, v214, v134, v135
    v_max3_f32 v215, v215, v136, v137
    v_max3_f32 v214, v214, v138, v139
    v_max3_f32 v215, v215, v140, v141
    v_max3_f32 v214, v214, v142, v143
    v_max3_f32 v215, v215, v144, v145
    v_max3_f32 v214, v214, v146, v147
    v_max3_f32 v215, v215, v148, v149
    v_max3_f32 v214, v214, v150, v151
    v_max3_f32 v215, v215, v152, v153
    v_max3_f32 v214, v214, v154, v155
    v_max3_f32 v215, v215, v156, v157
    v_max3_f32 v214, v214, v158, v159
    v_max_f32 v214, v214, v215
    v_mov_b32 v215, v214
    s_nop 1
    v_permlane32_swap_b32 v214, v215
    v_max_f32 v214, v214, v215
    v_mul_f32 v140, -1.0, v214
    v_mul_f32 v141, -1.0, v214
    v_mul_f32 v142, -1.0, v214
    v_mul_f32 v143, -1.0, v214
    v_mul_f32 v144, -1.0, v214
    v_mul_f32 v145, -1.0, v214
    v_mul_f32 v146, -1.0, v214
    v_mul_f32 v147, -1.0, v214
    v_mul_f32 v148, -1.0, v214
    v_mul_f32 v149, -1.0, v214
    v_mul_f32 v150, -1.0, v214
    v_mul_f32 v151, -1.0, v214
    v_mul_f32 v152, -1.0, v214
    v_mul_f32 v153, -1.0, v214
    v_mul_f32 v154, -1.0, v214
    v_mul_f32 v155, -1.0, v214
    s_nop 1
    v_mfma_f32_32x32x16_bf16 v[108:123], v[20:23], v[192:195], v[140:155]
    v_mfma_f32_32x32x16_bf16 v[124:139], v[24:27], v[192:195], v[140:155]
    s_nop 10
    v_exp_f32 v108, v108
    v_exp_f32 v109, v109
    v_exp_f32 v110, v110
    v_exp_f32 v111, v111
    v_exp_f32 v112, v112
    v_exp_f32 v113, v113
    v_exp_f32 v114, v114
    v_exp_f32 v115, v115
    v_cvt_pk_bf16_f32 v196, v108, v109
    v_cvt_pk_bf16_f32 v197, v110, v111
    v_cvt_pk_bf16_f32 v198, v112, v113
    v_cvt_pk_bf16_f32 v199, v114, v115
    s_nop 1
    v_mfma_f32_32x32x16_bf16 v[156:171], v[52:55], v[196:199], 0
    v_exp_f32 v116, v116
    v_exp_f32 v117, v117
    v_exp_f32 v118, v118
    v_exp_f32 v119, v119
    v_exp_f32 v120, v120
    v_exp_f32 v121, v121
    v_exp_f32 v122, v122
    v_exp_f32 v123, v123
    v_cvt_pk_bf16_f32 v200, v116, v117
    v_cvt_pk_bf16_f32 v201, v118, v119
    v_cvt_pk_bf16_f32 v202, v120, v121
    v_cvt_pk_bf16_f32 v203, v122, v123
    s_nop 1
    v_mfma_f32_32x32x16_bf16 v[156:171], v[56:59], v[200:203], v[156:171]
    v_mfma_f32_32x32x16_bf16 v[108:123], v[28:31], v[192:195], v[140:155]
    v_exp_f32 v124, v124
    v_exp_f32 v125, v125
    v_exp_f32 v126, v126
    v_exp_f32 v127, v127
    v_exp_f32 v128, v128
    v_exp_f32 v129, v129
    v_exp_f32 v130, v130
    v_exp_f32 v131, v131
    v_cvt_pk_bf16_f32 v196, v124, v125
    v_cvt_pk_bf16_f32 v197, v126, v127
    v_cvt_pk_bf16_f32 v198, v128, v129
    v_cvt_pk_bf16_f32 v199, v130, v131
    s_nop 1
    v_mfma_f32_32x32x16_bf16 v[156:171], v[60:63], v[196:199], v[156:171]
    v_exp_f32 v132, v132
    v_exp_f32 v133, v133
    v_exp_f32 v134, v134
    v_exp_f32 v135, v135
    v_exp_f32 v136, v136
    v_exp_f32 v137, v137
    v_exp_f32 v138, v138
    v_exp_f32 v139, v139
    v_cvt_pk_bf16_f32 v200, v132, v133
    v_cvt_pk_bf16_f32 v201, v134, v135
    v_cvt_pk_bf16_f32 v202, v136, v137
    v_cvt_pk_bf16_f32 v203, v138, v139
    s_nop 1
    v_mfma_f32_32x32x16_bf16 v[156:171], v[64:67], v[200:203], v[156:171]
    v_mfma_f32_32x32x16_bf16 v[124:139], v[32:35], v[192:195], v[140:155]
    v_exp_f32 v108, v108
    v_exp_f32 v109, v109
    v_exp_f32 v110, v110
    v_exp_f32 v111, v111
    v_exp_f32 v112, v112
    v_exp_f32 v113, v113
    v_exp_f32 v114, v114
    v_exp_f32 v115, v115
    v_cvt_pk_bf16_f32 v196, v108, v109
    v_cvt_pk_bf16_f32 v197, v110, v111
    v_cvt_pk_bf16_f32 v198, v112, v113
    v_cvt_pk_bf16_f32 v199, v114, v115
    s_nop 1
    v_mfma_f32_32x32x16_bf16 v[156:171], v[68:71], v[196:199], v[156:171]
    v_exp_f32 v116, v116
    v_exp_f32 v117, v117
    v_exp_f32 v118, v118
    v_exp_f32 v119, v119
    v_exp_f32 v120, v120
    v_exp_f32 v121, v121
    v_exp_f32 v122, v122
    v_exp_f32 v123, v123
    v_cvt_pk_bf16_f32 v200, v116, v117
    v_cvt_pk_bf16_f32 v201, v118, v119
    v_cvt_pk_bf16_f32 v202, v120, v121
    v_cvt_pk_bf16_f32 v203, v122, v123
    s_nop 1
    v_mfma_f32_32x32x16_bf16 v[156:171], v[72:75], v[200:203], v[156:171]
    v_exp_f32 v124, v124
    v_exp_f32 v125, v125
    v_exp_f32 v126, v126
    v_exp_f32 v127, v127
    v_cvt_pk_bf16_f32 v196, v124, v125
    v_cvt_pk_bf16_f32 v197, v126, v127
    v_mov_b32 v198, 0
    v_mov_b32 v199, 0
    s_nop 1
    v_mfma_f32_32x32x16_bf16 v[156:171], v[76:79], v[196:199], v[156:171]
    s_nop 11
    v_rcp_f32 v216, v164
    s_add_u32 s47, s28, 2048
    v_fma_f32 v212, v156, v216, v208
    v_fma_f32 v213, v157, v216, v209
    v_fma_f32 v214, v158, v216, v210
    v_fma_f32 v215, v159, v216, v211
    v_cvt_pk_bf16_f32 v212, v212, v213
    v_cvt_pk_bf16_f32 v213, v214, v215
    v_pk_max_i16 v212, v212, 0
    v_pk_max_i16 v213, v213, 0
    buffer_store_dwordx2 v[212:213], v5, s[8:11], s47 offen offset:0
    v_cmp_le_u32 s[40:41], 4, v1
    v_mov_b32 v212, 3072
    v_mov_b32 v213, -128
    v_cndmask_b32_e64 v212, v212, v213, s[40:41]
    v_add_u32 v212, v3, v212
    buffer_load_dwordx4 v[188:191], v212, s[4:7], s28 offen
    s_waitcnt vmcnt(0)
    v_cmp_le_u32 s[38:39], 4, v1
    v_mfma_f32_32x32x16_bf16 v[172:187], v[12:15], v[188:191], 0
    s_nop 0
    v_cndmask_b32_e64 v216, v16, v17, s[38:39]
    v_mov_b32 v140, v216
    v_mov_b32 v141, v216
    v_mov_b32 v142, v216
    v_mov_b32 v143, v216
    v_mov_b32 v144, v216
    v_mov_b32 v145, v216
    v_mov_b32 v146, v216
    v_mov_b32 v147, v216
    v_mov_b32 v148, v216
    v_mov_b32 v149, v216
    v_mov_b32 v150, v216
    v_mov_b32 v151, v216
    v_mov_b32 v152, v216
    v_mov_b32 v153, v216
    v_mov_b32 v154, v216
    v_mov_b32 v155, v216
    v_cvt_pk_bf16_f32 v204, v172, v173
    v_cvt_pk_bf16_f32 v205, v174, v175
    v_cvt_pk_bf16_f32 v206, v176, v177
    v_cvt_pk_bf16_f32 v207, v178, v179
    v_cndmask_b32_e64 v217, v7, v8, s[38:39]
    v_and_b32 v204, v204, v217
    v_and_b32 v205, v205, v217
    v_and_b32 v206, v206, v217
    v_and_b32 v207, v207, v217
    v_cndmask_b32_e64 v244, v180, v184, s[38:39]
    v_cndmask_b32_e64 v245, v181, v185, s[38:39]
    v_cndmask_b32_e64 v246, v182, v186, s[38:39]
    v_cndmask_b32_e64 v247, v183, v187, s[38:39]
    v_mfma_f32_32x32x16_bf16 v[108:123], v[20:23], v[204:207], v[140:155]
    v_mfma_f32_32x32x16_bf16 v[124:139], v[24:27], v[204:207], v[140:155]
    s_add_u32 s46, s28, 896
    buffer_load_dwordx4 v[188:191], v3, s[4:7], s46 offen
    s_waitcnt vmcnt(0)
    s_nop 15
    s_branch L_after_2
L_fb_3:
    s_nop 15
    s_waitcnt vmcnt(0)
    v_cmp_le_u32 s[40:41], 4, v1
    v_mov_b32 v212, 3072
    v_mov_b32 v213, -128
    v_cndmask_b32_e64 v212, v212, v213, s[40:41]
    v_add_u32 v212, v3, v212
    buffer_load_dwordx4 v[188:191], v212, s[4:7], s28 offen
    s_waitcnt vmcnt(0)
    v_cmp_le_u32 s[38:39], 4, v1
    v_mfma_f32_32x32x16_bf16 v[172:187], v[12:15], v[188:191], 0
    s_nop 11
    v_cvt_pk_bf16_f32 v204, v172, v173
    v_cvt_pk_bf16_f32 v205, v174, v175
    v_cvt_pk_bf16_f32 v206, v176, v177
    v_cvt_pk_bf16_f32 v207, v178, v179
    v_cndmask_b32_e64 v217, v7, v8, s[38:39]
    v_and_b32 v204, v204, v217
    v_and_b32 v205, v205, v217
    v_and_b32 v206, v206, v217
    v_and_b32 v207, v207, v217
    v_cndmask_b32_e64 v244, v180, v184, s[38:39]
    v_cndmask_b32_e64 v245, v181, v185, s[38:39]
    v_cndmask_b32_e64 v246, v182, v186, s[38:39]
    v_cndmask_b32_e64 v247, v183, v187, s[38:39]
    v_mfma_f32_32x32x16_bf16 v[108:123], v[20:23], v[204:207], 0
    v_mfma_f32_32x32x16_bf16 v[124:139], v[24:27], v[204:207], 0
    v_mfma_f32_32x32x16_bf16 v[140:155], v[28:31], v[204:207], 0
    v_mfma_f32_32x32x16_bf16 v[156:171], v[32:35], v[204:207], 0
    s_nop 8
    v_max3_f32 v214, v108, v109, v110
    v_max3_f32 v215, v111, v112, v113
    v_max3_f32 v214, v214, v114, v115
    v_max3_f32 v215, v215, v116, v117
    v_max3_f32 v214, v214, v118, v119
    v_max3_f32 v215, v215, v120, v121
    v_max3_f32 v214, v214, v122, v123
    v_max3_f32 v215, v215, v124, v125
    v_max3_f32 v214, v214, v126, v127
    v_max3_f32 v215, v215, v128, v129
    v_max3_f32 v214, v214, v130, v131
    v_max3_f32 v215, v215, v132, v133
    v_max3_f32 v214, v214, v134, v135
    v_max3_f32 v215, v215, v136, v137
    v_max3_f32 v214, v214, v138, v139
    v_max3_f32 v215, v215, v140, v141
    v_max3_f32 v214, v214, v142, v143
    v_max3_f32 v215, v215, v144, v145
    v_max3_f32 v214, v214, v146, v147
    v_max3_f32 v215, v215, v148, v149
    v_max3_f32 v214, v214, v150, v151
    v_max3_f32 v215, v215, v152, v153
    v_max3_f32 v214, v214, v154, v155
    v_max3_f32 v215, v215, v156, v157
    v_max3_f32 v214, v214, v158, v159
    v_max_f32 v214, v214, v215
    v_mov_b32 v215, v214
    s_nop 1
    v_permlane32_swap_b32 v214, v215
    v_max_f32 v214, v214, v215
    v_mul_f32 v140, -1.0, v214
    v_mul_f32 v141, -1.0, v214
    v_mul_f32 v142, -1.0, v214
    v_mul_f32 v143, -1.0, v214
    v_mul_f32 v144, -1.0, v214
    v_mul_f32 v145, -1.0, v214
    v_mul_f32 v146, -1.0, v214
    v_mul_f32 v147, -1.0, v214
    v_mul_f32 v148, -1.0, v214
    v_mul_f32 v149, -1.0, v214
    v_mul_f32 v150, -1.0, v214
    v_mul_f32 v151, -1.0, v214
    v_mul_f32 v152, -1.0, v214
    v_mul_f32 v153, -1.0, v214
    v_mul_f32 v154, -1.0, v214
    v_mul_f32 v155, -1.0, v214
    s_nop 1
    v_mfma_f32_32x32x16_bf16 v[108:123], v[20:23], v[204:207], v[140:155]
    v_mfma_f32_32x32x16_bf16 v[124:139], v[24:27], v[204:207], v[140:155]
    s_nop 10
    v_exp_f32 v108, v108
    v_exp_f32 v109, v109
    v_exp_f32 v110, v110
    v_exp_f32 v111, v111
    v_exp_f32 v112, v112
    v_exp_f32 v113, v113
    v_exp_f32 v114, v114
    v_exp_f32 v115, v115
    v_cvt_pk_bf16_f32 v196, v108, v109
    v_cvt_pk_bf16_f32 v197, v110, v111
    v_cvt_pk_bf16_f32 v198, v112, v113
    v_cvt_pk_bf16_f32 v199, v114, v115
    s_nop 1
    v_mfma_f32_32x32x16_bf16 v[156:171], v[52:55], v[196:199], 0
    v_exp_f32 v116, v116
    v_exp_f32 v117, v117
    v_exp_f32 v118, v118
    v_exp_f32 v119, v119
    v_exp_f32 v120, v120
    v_exp_f32 v121, v121
    v_exp_f32 v122, v122
    v_exp_f32 v123, v123
    v_cvt_pk_bf16_f32 v200, v116, v117
    v_cvt_pk_bf16_f32 v201, v118, v119
    v_cvt_pk_bf16_f32 v202, v120, v121
    v_cvt_pk_bf16_f32 v203, v122, v123
    s_nop 1
    v_mfma_f32_32x32x16_bf16 v[156:171], v[56:59], v[200:203], v[156:171]
    v_mfma_f32_32x32x16_bf16 v[108:123], v[28:31], v[204:207], v[140:155]
    v_exp_f32 v124, v124
    v_exp_f32 v125, v125
    v_exp_f32 v126, v126
    v_exp_f32 v127, v127
    v_exp_f32 v128, v128
    v_exp_f32 v129, v129
    v_exp_f32 v130, v130
    v_exp_f32 v131, v131
    v_cvt_pk_bf16_f32 v196, v124, v125
    v_cvt_pk_bf16_f32 v197, v126, v127
    v_cvt_pk_bf16_f32 v198, v128, v129
    v_cvt_pk_bf16_f32 v199, v130, v131
    s_nop 1
    v_mfma_f32_32x32x16_bf16 v[156:171], v[60:63], v[196:199], v[156:171]
    v_exp_f32 v132, v132
    v_exp_f32 v133, v133
    v_exp_f32 v134, v134
    v_exp_f32 v135, v135
    v_exp_f32 v136, v136
    v_exp_f32 v137, v137
    v_exp_f32 v138, v138
    v_exp_f32 v139, v139
    v_cvt_pk_bf16_f32 v200, v132, v133
    v_cvt_pk_bf16_f32 v201, v134, v135
    v_cvt_pk_bf16_f32 v202, v136, v137
    v_cvt_pk_bf16_f32 v203, v138, v139
    s_nop 1
    v_mfma_f32_32x32x16_bf16 v[156:171], v[64:67], v[200:203], v[156:171]
    v_mfma_f32_32x32x16_bf16 v[124:139], v[32:35], v[204:207], v[140:155]
    v_exp_f32 v108, v108
    v_exp_f32 v109, v109
    v_exp_f32 v110, v110
    v_exp_f32 v111, v111
    v_exp_f32 v112, v112
    v_exp_f32 v113, v113
    v_exp_f32 v114, v114
    v_exp_f32 v115, v115
    v_cvt_pk_bf16_f32 v196, v108, v109
    v_cvt_pk_bf16_f32 v197, v110, v111
    v_cvt_pk_bf16_f32 v198, v112, v113
    v_cvt_pk_bf16_f32 v199, v114, v115
    s_nop 1
    v_mfma_f32_32x32x16_bf16 v[156:171], v[68:71], v[196:199], v[156:171]
    v_exp_f32 v116, v116
    v_exp_f32 v117, v117
    v_exp_f32 v118, v118
    v_exp_f32 v119, v119
    v_exp_f32 v120, v120
    v_exp_f32 v121, v121
    v_exp_f32 v122, v122
    v_exp_f32 v123, v123
    v_cvt_pk_bf16_f32 v200, v116, v117
    v_cvt_pk_bf16_f32 v201, v118, v119
    v_cvt_pk_bf16_f32 v202, v120, v121
    v_cvt_pk_bf16_f32 v203, v122, v123
    s_nop 1
    v_mfma_f32_32x32x16_bf16 v[156:171], v[72:75], v[200:203], v[156:171]
    v_exp_f32 v124, v124
    v_exp_f32 v125, v125
    v_exp_f32 v126, v126
    v_exp_f32 v127, v127
    v_cvt_pk_bf16_f32 v196, v124, v125
    v_cvt_pk_bf16_f32 v197, v126, v127
    v_mov_b32 v198, 0
    v_mov_b32 v199, 0
    s_nop 1
    v_mfma_f32_32x32x16_bf16 v[156:171], v[76:79], v[196:199], v[156:171]
    s_nop 11
    v_rcp_f32 v216, v164
    v_cndmask_b32_e64 v212, v156, v160, s[38:39]
    v_cndmask_b32_e64 v213, v157, v161, s[38:39]
    v_cndmask_b32_e64 v214, v158, v162, s[38:39]
    v_cndmask_b32_e64 v215, v159, v163, s[38:39]
    v_mov_b32 v217, 3072
    v_mov_b32 v218, 0xffffff90
    v_cndmask_b32_e64 v217, v217, v218, s[38:39]
    v_add_u32 v217, v5, v217
    v_fma_f32 v212, v212, v216, v244
    v_fma_f32 v213, v213, v216, v245
    v_fma_f32 v214, v214, v216, v246
    v_fma_f32 v215, v215, v216, v247
    v_cvt_pk_bf16_f32 v212, v212, v213
    v_cvt_pk_bf16_f32 v213, v214, v215
    v_pk_max_i16 v212, v212, 0
    v_pk_max_i16 v213, v213, 0
    buffer_store_dwordx2 v[212:213], v217, s[8:11], s28 offen offset:0
    s_add_u32 s46, s28, 896
    buffer_load_dwordx4 v[188:191], v3, s[4:7], s46 offen
    s_waitcnt vmcnt(0)
    v_mfma_f32_32x32x16_bf16 v[172:187], v[12:15], v[188:191], 0
    v_mov_b32 v140, v17
    v_mov_b32 v141, v17
    v_mov_b32 v142, v17
    v_mov_b32 v143, v17
    v_mov_b32 v144, v17
    v_mov_b32 v145, v17
    v_mov_b32 v146, v17
    v_mov_b32 v147, v17
    v_mov_b32 v148, v17
    v_mov_b32 v149, v17
    v_mov_b32 v150, v17
    v_mov_b32 v151, v17
    v_mov_b32 v152, v17
    v_mov_b32 v153, v17
    v_mov_b32 v154, v17
    v_mov_b32 v155, v17
    v_cvt_pk_bf16_f32 v192, v172, v173
    v_cvt_pk_bf16_f32 v193, v174, v175
    v_cvt_pk_bf16_f32 v194, v176, v177
    v_cvt_pk_bf16_f32 v195, v178, v179
    v_and_b32 v192, v192, v8
    v_and_b32 v193, v193, v8
    v_and_b32 v194, v194, v8
    v_and_b32 v195, v195, v8
    v_mov_b32 v208, v184
    v_mov_b32 v209, v185
    v_mov_b32 v210, v186
    v_mov_b32 v211, v187
    v_mfma_f32_32x32x16_bf16 v[108:123], v[20:23], v[192:195], v[140:155]
    v_mfma_f32_32x32x16_bf16 v[124:139], v[24:27], v[192:195], v[140:155]
    s_add_u32 s46, s28, 1920
    buffer_load_dwordx4 v[188:191], v3, s[4:7], s46 offen
    s_waitcnt vmcnt(0)
    s_nop 15
    s_branch L_after_3
L_fb_4:
    s_nop 15
    s_waitcnt vmcnt(0)
    s_add_u32 s46, s28, 896
    buffer_load_dwordx4 v[188:191], v3, s[4:7], s46 offen
    s_waitcnt vmcnt(0)
    v_mfma_f32_32x32x16_bf16 v[172:187], v[12:15], v[188:191], 0
    s_nop 11
    v_cvt_pk_bf16_f32 v192, v172, v173
    v_cvt_pk_bf16_f32 v193, v174, v175
    v_cvt_pk_bf16_f32 v194, v176, v177
    v_cvt_pk_bf16_f32 v195, v178, v179
    v_and_b32 v192, v192, v8
    v_and_b32 v193, v193, v8
    v_and_b32 v194, v194, v8
    v_and_b32 v195, v195, v8
    v_mov_b32 v208, v184
    v_mov_b32 v209, v185
    v_mov_b32 v210, v186
    v_mov_b32 v211, v187
    v_mfma_f32_32x32x16_bf16 v[108:123], v[20:23], v[192:195], 0
    v_mfma_f32_32x32x16_bf16 v[124:139], v[24:27], v[192:195], 0
    v_mfma_f32_32x32x16_bf16 v[140:155], v[28:31], v[192:195], 0
    v_mfma_f32_32x32x16_bf16 v[156:171], v[32:35], v[192:195], 0
    s_nop 8
    v_max3_f32 v214, v108, v109, v110
    v_max3_f32 v215, v111, v112, v113
    v_max3_f32 v214, v214, v114, v115
    v_max3_f32 v215, v215, v116, v117
    v_max3_f32 v214, v214, v118, v119
    v_max3_f32 v215, v215, v120, v121
    v_max3_f32 v214, v214, v122, v123
    v_max3_f32 v215, v215, v124, v125
    v_max3_f32 v214, v214, v126, v127
    v_max3_f32 v215, v215, v128, v129
    v_max3_f32 v214, v214, v130, v131
    v_max3_f32 v215, v215, v132, v133
    v_max3_f32 v214, v214, v134, v135
    v_max3_f32 v215, v215, v136, v137
    v_max3_f32 v214, v214, v138, v139
    v_max3_f32 v215, v215, v140, v141
    v_max3_f32 v214, v214, v142, v143
    v_max3_f32 v215, v215, v144, v145
    v_max3_f32 v214, v214, v146, v147
    v_max3_f32 v215, v215, v148, v149
    v_max3_f32 v214, v214, v150, v151
    v_max3_f32 v215, v215, v152, v153
    v_max3_f32 v214, v214, v154, v155
    v_max3_f32 v215, v215, v156, v157
    v_max3_f32 v214, v214, v158, v159
    v_max_f32 v214, v214, v215
    v_mov_b32 v215, v214
    s_nop 1
    v_permlane32_swap_b32 v214, v215
    v_max_f32 v214, v214, v215
    v_mul_f32 v140, -1.0, v214
    v_mul_f32 v141, -1.0, v214
    v_mul_f32 v142, -1.0, v214
    v_mul_f32 v143, -1.0, v214
    v_mul_f32 v144, -1.0, v214
    v_mul_f32 v145, -1.0, v214
    v_mul_f32 v146, -1.0, v214
    v_mul_f32 v147, -1.0, v214
    v_mul_f32 v148, -1.0, v214
    v_mul_f32 v149, -1.0, v214
    v_mul_f32 v150, -1.0, v214
    v_mul_f32 v151, -1.0, v214
    v_mul_f32 v152, -1.0, v214
    v_mul_f32 v153, -1.0, v214
    v_mul_f32 v154, -1.0, v214
    v_mul_f32 v155, -1.0, v214
    s_nop 1
    v_mfma_f32_32x32x16_bf16 v[108:123], v[20:23], v[192:195], v[140:155]
    v_mfma_f32_32x32x16_bf16 v[124:139], v[24:27], v[192:195], v[140:155]
    s_nop 10
    v_exp_f32 v108, v108
    v_exp_f32 v109, v109
    v_exp_f32 v110, v110
    v_exp_f32 v111, v111
    v_exp_f32 v112, v112
    v_exp_f32 v113, v113
    v_exp_f32 v114, v114
    v_exp_f32 v115, v115
    v_cvt_pk_bf16_f32 v196, v108, v109
    v_cvt_pk_bf16_f32 v197, v110, v111
    v_cvt_pk_bf16_f32 v198, v112, v113
    v_cvt_pk_bf16_f32 v199, v114, v115
    s_nop 1
    v_mfma_f32_32x32x16_bf16 v[156:171], v[52:55], v[196:199], 0
    v_exp_f32 v116, v116
    v_exp_f32 v117, v117
    v_exp_f32 v118, v118
    v_exp_f32 v119, v119
    v_exp_f32 v120, v120
    v_exp_f32 v121, v121
    v_exp_f32 v122, v122
    v_exp_f32 v123, v123
    v_cvt_pk_bf16_f32 v200, v116, v117
    v_cvt_pk_bf16_f32 v201, v118, v119
    v_cvt_pk_bf16_f32 v202, v120, v121
    v_cvt_pk_bf16_f32 v203, v122, v123
    s_nop 1
    v_mfma_f32_32x32x16_bf16 v[156:171], v[56:59], v[200:203], v[156:171]
    v_mfma_f32_32x32x16_bf16 v[108:123], v[28:31], v[192:195], v[140:155]
    v_exp_f32 v124, v124
    v_exp_f32 v125, v125
    v_exp_f32 v126, v126
    v_exp_f32 v127, v127
    v_exp_f32 v128, v128
    v_exp_f32 v129, v129
    v_exp_f32 v130, v130
    v_exp_f32 v131, v131
    v_cvt_pk_bf16_f32 v196, v124, v125
    v_cvt_pk_bf16_f32 v197, v126, v127
    v_cvt_pk_bf16_f32 v198, v128, v129
    v_cvt_pk_bf16_f32 v199, v130, v131
    s_nop 1
    v_mfma_f32_32x32x16_bf16 v[156:171], v[60:63], v[196:199], v[156:171]
    v_exp_f32 v132, v132
    v_exp_f32 v133, v133
    v_exp_f32 v134, v134
    v_exp_f32 v135, v135
    v_exp_f32 v136, v136
    v_exp_f32 v137, v137
    v_exp_f32 v138, v138
    v_exp_f32 v139, v139
    v_cvt_pk_bf16_f32 v200, v132, v133
    v_cvt_pk_bf16_f32 v201, v134, v135
    v_cvt_pk_bf16_f32 v202, v136, v137
    v_cvt_pk_bf16_f32 v203, v138, v139
    s_nop 1
    v_mfma_f32_32x32x16_bf16 v[156:171], v[64:67], v[200:203], v[156:171]
    v_mfma_f32_32x32x16_bf16 v[124:139], v[32:35], v[192:195], v[140:155]
    v_exp_f32 v108, v108
    v_exp_f32 v109, v109
    v_exp_f32 v110, v110
    v_exp_f32 v111, v111
    v_exp_f32 v112, v112
    v_exp_f32 v113, v113
    v_exp_f32 v114, v114
    v_exp_f32 v115, v115
    v_cvt_pk_bf16_f32 v196, v108, v109
    v_cvt_pk_bf16_f32 v197, v110, v111
    v_cvt_pk_bf16_f32 v198, v112, v113
    v_cvt_pk_bf16_f32 v199, v114, v115
    s_nop 1
    v_mfma_f32_32x32x16_bf16 v[156:171], v[68:71], v[196:199], v[156:171]
    v_exp_f32 v116, v116
    v_exp_f32 v117, v117
    v_exp_f32 v118, v118
    v_exp_f32 v119, v119
    v_exp_f32 v120, v120
    v_exp_f32 v121, v121
    v_exp_f32 v122, v122
    v_exp_f32 v123, v123
    v_cvt_pk_bf16_f32 v200, v116, v117
    v_cvt_pk_bf16_f32 v201, v118, v119
    v_cvt_pk_bf16_f32 v202, v120, v121
    v_cvt_pk_bf16_f32 v203, v122, v123
    s_nop 1
    v_mfma_f32_32x32x16_bf16 v[156:171], v[72:75], v[200:203], v[156:171]
    v_exp_f32 v124, v124
    v_exp_f32 v125, v125
    v_exp_f32 v126, v126
    v_exp_f32 v127, v127
    v_cvt_pk_bf16_f32 v196, v124, v125
    v_cvt_pk_bf16_f32 v197, v126, v127
    v_mov_b32 v198, 0
    v_mov_b32 v199, 0
    s_nop 1
    v_mfma_f32_32x32x16_bf16 v[156:171], v[76:79], v[196:199], v[156:171]
    s_nop 11
    v_rcp_f32 v216, v164
    s_add_u32 s47, s28, 896
    v_fma_f32 v212, v160, v216, v208
    v_fma_f32 v213, v161, v216, v209
    v_fma_f32 v214, v162, v216, v210
    v_fma_f32 v215, v163, v216, v211
    v_cvt_pk_bf16_f32 v212, v212, v213
    v_cvt_pk_bf16_f32 v213, v214, v215
    v_pk_max_i16 v212, v212, 0
    v_pk_max_i16 v213, v213, 0
    buffer_store_dwordx2 v[212:213], v5, s[8:11], s47 offen offset:16
    s_waitcnt vmcnt(0)
    s_nop 15
    s_branch L_after_4
L_fb_5:
    s_nop 15
    s_waitcnt vmcnt(0)
    s_add_u32 s46, s28, 1920
    buffer_load_dwordx4 v[188:191], v3, s[4:7], s46 offen
    s_waitcnt vmcnt(0)
    v_mfma_f32_32x32x16_bf16 v[172:187], v[12:15], v[188:191], 0
    s_nop 11
    v_cvt_pk_bf16_f32 v204, v172, v173
    v_cvt_pk_bf16_f32 v205, v174, v175
    v_cvt_pk_bf16_f32 v206, v176, v177
    v_cvt_pk_bf16_f32 v207, v178, v179
    v_and_b32 v204, v204, v8
    v_and_b32 v205, v205, v8
    v_and_b32 v206, v206, v8
    v_and_b32 v207, v207, v8
    v_mov_b32 v244, v184
    v_mov_b32 v245, v185
    v_mov_b32 v246, v186
    v_mov_b32 v247, v187
    v_mfma_f32_32x32x16_bf16 v[108:123], v[20:23], v[204:207], 0
    v_mfma_f32_32x32x16_bf16 v[124:139], v[24:27], v[204:207], 0
    v_mfma_f32_32x32x16_bf16 v[140:155], v[28:31], v[204:207], 0
    v_mfma_f32_32x32x16_bf16 v[156:171], v[32:35], v[204:207], 0
    s_nop 8
    v_max3_f32 v214, v108, v109, v110
    v_max3_f32 v215, v111, v112, v113
    v_max3_f32 v214, v214, v114, v115
    v_max3_f32 v215, v215, v116, v117
    v_max3_f32 v214, v214, v118, v119
    v_max3_f32 v215, v215, v120, v121
    v_max3_f32 v214, v214, v122, v123
    v_max3_f32 v215, v215, v124, v125
    v_max3_f32 v214, v214, v126, v127
    v_max3_f32 v215, v215, v128, v129
    v_max3_f32 v214, v214, v130, v131
    v_max3_f32 v215, v215, v132, v133
    v_max3_f32 v214, v214, v134, v135
    v_max3_f32 v215, v215, v136, v137
    v_max3_f32 v214, v214, v138, v139
    v_max3_f32 v215, v215, v140, v141
    v_max3_f32 v214, v214, v142, v143
    v_max3_f32 v215, v215, v144, v145
    v_max3_f32 v214, v214, v146, v147
    v_max3_f32 v215, v215, v148, v149
    v_max3_f32 v214, v214, v150, v151
    v_max3_f32 v215, v215, v152, v153
    v_max3_f32 v214, v214, v154, v155
    v_max3_f32 v215, v215, v156, v157
    v_max3_f32 v214, v214, v158, v159
    v_max_f32 v214, v214, v215
    v_mov_b32 v215, v214
    s_nop 1
    v_permlane32_swap_b32 v214, v215
    v_max_f32 v214, v214, v215
    v_mul_f32 v140, -1.0, v214
    v_mul_f32 v141, -1.0, v214
    v_mul_f32 v142, -1.0, v214
    v_mul_f32 v143, -1.0, v214
    v_mul_f32 v144, -1.0, v214
    v_mul_f32 v145, -1.0, v214
    v_mul_f32 v146, -1.0, v214
    v_mul_f32 v147, -1.0, v214
    v_mul_f32 v148, -1.0, v214
    v_mul_f32 v149, -1.0, v214
    v_mul_f32 v150, -1.0, v214
    v_mul_f32 v151, -1.0, v214
    v_mul_f32 v152, -1.0, v214
    v_mul_f32 v153, -1.0, v214
    v_mul_f32 v154, -1.0, v214
    v_mul_f32 v155, -1.0, v214
    s_nop 1
    v_mfma_f32_32x32x16_bf16 v[108:123], v[20:23], v[204:207], v[140:155]
    v_mfma_f32_32x32x16_bf16 v[124:139], v[24:27], v[204:207], v[140:155]
    s_nop 10
    v_exp_f32 v108, v108
    v_exp_f32 v109, v109
    v_exp_f32 v110, v110
    v_exp_f32 v111, v111
    v_exp_f32 v112, v112
    v_exp_f32 v113, v113
    v_exp_f32 v114, v114
    v_exp_f32 v115, v115
    v_cvt_pk_bf16_f32 v196, v108, v109
    v_cvt_pk_bf16_f32 v197, v110, v111
    v_cvt_pk_bf16_f32 v198, v112, v113
    v_cvt_pk_bf16_f32 v199, v114, v115
    s_nop 1
    v_mfma_f32_32x32x16_bf16 v[156:171], v[52:55], v[196:199], 0
    v_exp_f32 v116, v116
    v_exp_f32 v117, v117
    v_exp_f32 v118, v118
    v_exp_f32 v119, v119
    v_exp_f32 v120, v120
    v_exp_f32 v121, v121
    v_exp_f32 v122, v122
    v_exp_f32 v123, v123
    v_cvt_pk_bf16_f32 v200, v116, v117
    v_cvt_pk_bf16_f32 v201, v118, v119
    v_cvt_pk_bf16_f32 v202, v120, v121
    v_cvt_pk_bf16_f32 v203, v122, v123
    s_nop 1
    v_mfma_f32_32x32x16_bf16 v[156:171], v[56:59], v[200:203], v[156:171]
    v_mfma_f32_32x32x16_bf16 v[108:123], v[28:31], v[204:207], v[140:155]
    v_exp_f32 v124, v124
    v_exp_f32 v125, v125
    v_exp_f32 v126, v126
    v_exp_f32 v127, v127
    v_exp_f32 v128, v128
    v_exp_f32 v129, v129
    v_exp_f32 v130, v130
    v_exp_f32 v131, v131
    v_cvt_pk_bf16_f32 v196, v124, v125
    v_cvt_pk_bf16_f32 v197, v126, v127
    v_cvt_pk_bf16_f32 v198, v128, v129
    v_cvt_pk_bf16_f32 v199, v130, v131
    s_nop 1
    v_mfma_f32_32x32x16_bf16 v[156:171], v[60:63], v[196:199], v[156:171]
    v_exp_f32 v132, v132
    v_exp_f32 v133, v133
    v_exp_f32 v134, v134
    v_exp_f32 v135, v135
    v_exp_f32 v136, v136
    v_exp_f32 v137, v137
    v_exp_f32 v138, v138
    v_exp_f32 v139, v139
    v_cvt_pk_bf16_f32 v200, v132, v133
    v_cvt_pk_bf16_f32 v201, v134, v135
    v_cvt_pk_bf16_f32 v202, v136, v137
    v_cvt_pk_bf16_f32 v203, v138, v139
    s_nop 1
    v_mfma_f32_32x32x16_bf16 v[156:171], v[64:67], v[200:203], v[156:171]
    v_mfma_f32_32x32x16_bf16 v[124:139], v[32:35], v[204:207], v[140:155]
    v_exp_f32 v108, v108
    v_exp_f32 v109, v109
    v_exp_f32 v110, v110
    v_exp_f32 v111, v111
    v_exp_f32 v112, v112
    v_exp_f32 v113, v113
    v_exp_f32 v114, v114
    v_exp_f32 v115, v115
    v_cvt_pk_bf16_f32 v196, v108, v109
    v_cvt_pk_bf16_f32 v197, v110, v111
    v_cvt_pk_bf16_f32 v198, v112, v113
    v_cvt_pk_bf16_f32 v199, v114, v115
    s_nop 1
    v_mfma_f32_32x32x16_bf16 v[156:171], v[68:71], v[196:199], v[156:171]
    v_exp_f32 v116, v116
    v_exp_f32 v117, v117
    v_exp_f32 v118, v118
    v_exp_f32 v119, v119
    v_exp_f32 v120, v120
    v_exp_f32 v121, v121
    v_exp_f32 v122, v122
    v_exp_f32 v123, v123
    v_cvt_pk_bf16_f32 v200, v116, v117
    v_cvt_pk_bf16_f32 v201, v118, v119
    v_cvt_pk_bf16_f32 v202, v120, v121
    v_cvt_pk_bf16_f32 v203, v122, v123
    s_nop 1
    v_mfma_f32_32x32x16_bf16 v[156:171], v[72:75], v[200:203], v[156:171]
    v_exp_f32 v124, v124
    v_exp_f32 v125, v125
    v_exp_f32 v126, v126
    v_exp_f32 v127, v127
    v_cvt_pk_bf16_f32 v196, v124, v125
    v_cvt_pk_bf16_f32 v197, v126, v127
    v_mov_b32 v198, 0
    v_mov_b32 v199, 0
    s_nop 1
    v_mfma_f32_32x32x16_bf16 v[156:171], v[76:79], v[196:199], v[156:171]
    s_nop 11
    v_rcp_f32 v216, v164
    s_add_u32 s47, s28, 1920
    v_fma_f32 v212, v160, v216, v244
    v_fma_f32 v213, v161, v216, v245
    v_fma_f32 v214, v162, v216, v246
    v_fma_f32 v215, v163, v216, v247
    v_cvt_pk_bf16_f32 v212, v212, v213
    v_cvt_pk_bf16_f32 v213, v214, v215
    v_pk_max_i16 v212, v212, 0
    v_pk_max_i16 v213, v213, 0
    buffer_store_dwordx2 v[212:213], v5, s[8:11], s47 offen offset:16
    s_waitcnt vmcnt(0)
    s_nop 15
    s_branch L_after_5
L_fb_6:
    s_nop 15
    s_waitcnt vmcnt(0)
    s_add_u32 s46, s28, 2944
    buffer_load_dwordx4 v[188:191], v3, s[4:7], s46 offen
    s_waitcnt vmcnt(0)
    v_cmp_le_u32 s[38:39], 8, v1
    v_mfma_f32_32x32x16_bf16 v[172:187], v[12:15], v[188:191], 0
    s_nop 11
    v_cvt_pk_bf16_f32 v192, v172, v173
    v_cvt_pk_bf16_f32 v193, v174, v175
    v_cvt_pk_bf16_f32 v194, v176, v177
    v_cvt_pk_bf16_f32 v195, v178, v179
    v_cndmask_b32_e64 v217, v8, v7, s[38:39]
    v_and_b32 v192, v192, v217
    v_and_b32 v193, v193, v217
    v_and_b32 v194, v194, v217
    v_and_b32 v195, v195, v217
    v_cndmask_b32_e64 v208, v184, v180, s[38:39]
    v_cndmask_b32_e64 v209, v185, v181, s[38:39]
    v_cndmask_b32_e64 v210, v186, v182, s[38:39]
    v_cndmask_b32_e64 v211, v187, v183, s[38:39]
    v_mfma_f32_32x32x16_bf16 v[108:123], v[20:23], v[192:195], 0
    v_mfma_f32_32x32x16_bf16 v[124:139], v[24:27], v[192:195], 0
    v_mfma_f32_32x32x16_bf16 v[140:155], v[28:31], v[192:195], 0
    v_mfma_f32_32x32x16_bf16 v[156:171], v[32:35], v[192:195], 0
    s_nop 8
    v_max3_f32 v214, v108, v109, v110
    v_max3_f32 v215, v111, v112, v113
    v_max3_f32 v214, v214, v114, v115
    v_max3_f32 v215, v215, v116, v117
    v_max3_f32 v214, v214, v118, v119
    v_max3_f32 v215, v215, v120, v121
    v_max3_f32 v214, v214, v122, v123
    v_max3_f32 v215, v215, v124, v125
    v_max3_f32 v214, v214, v126, v127
    v_max3_f32 v215, v215, v128, v129
    v_max3_f32 v214, v214, v130, v131
    v_max3_f32 v215, v215, v132, v133
    v_max3_f32 v214, v214, v134, v135
    v_max3_f32 v215, v215, v136, v137
    v_max3_f32 v214, v214, v138, v139
    v_max3_f32 v215, v215, v140, v141
    v_max3_f32 v214, v214, v142, v143
    v_max3_f32 v215, v215, v144, v145
    v_max3_f32 v214, v214, v146, v147
    v_max3_f32 v215, v215, v148, v149
    v_max3_f32 v214, v214, v150, v151
    v_max3_f32 v215, v215, v152, v153
    v_max3_f32 v214, v214, v154, v155
    v_max3_f32 v215, v215, v156, v157
    v_max3_f32 v214, v214, v158, v159
    v_max_f32 v214, v214, v215
    v_mov_b32 v215, v214
    s_nop 1
    v_permlane32_swap_b32 v214, v215
    v_max_f32 v214, v214, v215
    v_mul_f32 v140, -1.0, v214
    v_mul_f32 v141, -1.0, v214
    v_mul_f32 v142, -1.0, v214
    v_mul_f32 v143, -1.0, v214
    v_mul_f32 v144, -1.0, v214
    v_mul_f32 v145, -1.0, v214
    v_mul_f32 v146, -1.0, v214
    v_mul_f32 v147, -1.0, v214
    v_mul_f32 v148, -1.0, v214
    v_mul_f32 v149, -1.0, v214
    v_mul_f32 v150, -1.0, v214
    v_mul_f32 v151, -1.0, v214
    v_mul_f32 v152, -1.0, v214
    v_mul_f32 v153, -1.0, v214
    v_mul_f32 v154, -1.0, v214
    v_mul_f32 v155, -1.0, v214
    s_nop 1
    v_mfma_f32_32x32x16_bf16 v[108:123], v[20:23], v[192:195], v[140:155]
    v_mfma_f32_32x32x16_bf16 v[124:139], v[24:27], v[192:195], v[140:155]
    s_nop 10
    v_exp_f32 v108, v108
    v_exp_f32 v109, v109
    v_exp_f32 v110, v110
    v_exp_f32 v111, v111
    v_exp_f32 v112, v112
    v_exp_f32 v113, v113
    v_exp_f32 v114, v114
    v_exp_f32 v115, v115
    v_cvt_pk_bf16_f32 v196, v108, v109
    v_cvt_pk_bf16_f32 v197, v110, v111
    v_cvt_pk_bf16_f32 v198, v112, v113
    v_cvt_pk_bf16_f32 v199, v114, v115
    s_nop 1
    v_mfma_f32_32x32x16_bf16 v[156:171], v[52:55], v[196:199], 0
    v_exp_f32 v116, v116
    v_exp_f32 v117, v117
    v_exp_f32 v118, v118
    v_exp_f32 v119, v119
    v_exp_f32 v120, v120
    v_exp_f32 v121, v121
    v_exp_f32 v122, v122
    v_exp_f32 v123, v123
    v_cvt_pk_bf16_f32 v200, v116, v117
    v_cvt_pk_bf16_f32 v201, v118, v119
    v_cvt_pk_bf16_f32 v202, v120, v121
    v_cvt_pk_bf16_f32 v203, v122, v123
    s_nop 1
    v_mfma_f32_32x32x16_bf16 v[156:171], v[56:59], v[200:203], v[156:171]
    v_mfma_f32_32x32x16_bf16 v[108:123], v[28:31], v[192:195], v[140:155]
    v_exp_f32 v124, v124
    v_exp_f32 v125, v125
    v_exp_f32 v126, v126
    v_exp_f32 v127, v127
    v_exp_f32 v128, v128
    v_exp_f32 v129, v129
    v_exp_f32 v130, v130
    v_exp_f32 v131, v131
    v_cvt_pk_bf16_f32 v196, v124, v125
    v_cvt_pk_bf16_f32 v197, v126, v127
    v_cvt_pk_bf16_f32 v198, v128, v129
    v_cvt_pk_bf16_f32 v199, v130, v131
    s_nop 1
    v_mfma_f32_32x32x16_bf16 v[156:171], v[60:63], v[196:199], v[156:171]
    v_exp_f32 v132, v132
    v_exp_f32 v133, v133
    v_exp_f32 v134, v134
    v_exp_f32 v135, v135
    v_exp_f32 v136, v136
    v_exp_f32 v137, v137
    v_exp_f32 v138, v138
    v_exp_f32 v139, v139
    v_cvt_pk_bf16_f32 v200, v132, v133
    v_cvt_pk_bf16_f32 v201, v134, v135
    v_cvt_pk_bf16_f32 v202, v136, v137
    v_cvt_pk_bf16_f32 v203, v138, v139
    s_nop 1
    v_mfma_f32_32x32x16_bf16 v[156:171], v[64:67], v[200:203], v[156:171]
    v_mfma_f32_32x32x16_bf16 v[124:139], v[32:35], v[192:195], v[140:155]
    v_exp_f32 v108, v108
    v_exp_f32 v109, v109
    v_exp_f32 v110, v110
    v_exp_f32 v111, v111
    v_exp_f32 v112, v112
    v_exp_f32 v113, v113
    v_exp_f32 v114, v114
    v_exp_f32 v115, v115
    v_cvt_pk_bf16_f32 v196, v108, v109
    v_cvt_pk_bf16_f32 v197, v110, v111
    v_cvt_pk_bf16_f32 v198, v112, v113
    v_cvt_pk_bf16_f32 v199, v114, v115
    s_nop 1
    v_mfma_f32_32x32x16_bf16 v[156:171], v[68:71], v[196:199], v[156:171]
    v_exp_f32 v116, v116
    v_exp_f32 v117, v117
    v_exp_f32 v118, v118
    v_exp_f32 v119, v119
    v_exp_f32 v120, v120
    v_exp_f32 v121, v121
    v_exp_f32 v122, v122
    v_exp_f32 v123, v123
    v_cvt_pk_bf16_f32 v200, v116, v117
    v_cvt_pk_bf16_f32 v201, v118, v119
    v_cvt_pk_bf16_f32 v202, v120, v121
    v_cvt_pk_bf16_f32 v203, v122, v123
    s_nop 1
    v_mfma_f32_32x32x16_bf16 v[156:171], v[72:75], v[200:203], v[156:171]
    v_exp_f32 v124, v124
    v_exp_f32 v125, v125
    v_exp_f32 v126, v126
    v_exp_f32 v127, v127
    v_cvt_pk_bf16_f32 v196, v124, v125
    v_cvt_pk_bf16_f32 v197, v126, v127
    v_mov_b32 v198, 0
    v_mov_b32 v199, 0
    s_nop 1
    v_mfma_f32_32x32x16_bf16 v[156:171], v[76:79], v[196:199], v[156:171]
    s_nop 11
    v_rcp_f32 v216, v164
    v_cndmask_b32_e64 v212, v160, v156, s[38:39]
    v_cndmask_b32_e64 v213, v161, v157, s[38:39]
    v_cndmask_b32_e64 v214, v162, v158, s[38:39]
    v_cndmask_b32_e64 v215, v163, v159, s[38:39]
    v_mov_b32 v217, 2944
    v_mov_b32 v218, 0xb70
    v_cndmask_b32_e64 v217, v217, v218, s[38:39]
    v_add_u32 v217, v5, v217
    v_fma_f32 v212, v212, v216, v208
    v_fma_f32 v213, v213, v216, v209
    v_fma_f32 v214, v214, v216, v210
    v_fma_f32 v215, v215, v216, v211
    v_cvt_pk_bf16_f32 v212, v212, v213
    v_cvt_pk_bf16_f32 v213, v214, v215
    v_pk_max_i16 v212, v212, 0
    v_pk_max_i16 v213, v213, 0
    buffer_store_dwordx2 v[212:213], v217, s[8:11], s28 offen offset:16
    s_add_u32 s46, s28, 3968
    buffer_load_dwordx4 v[188:191], v3, s[4:7], s46 offen
    s_waitcnt vmcnt(0)
    v_mfma_f32_32x32x16_bf16 v[172:187], v[12:15], v[188:191], 0
    v_mov_b32 v140, v18
    v_mov_b32 v141, v18
    v_mov_b32 v142, v18
    v_mov_b32 v143, v18
    v_mov_b32 v144, v18
    v_mov_b32 v145, v18
    v_mov_b32 v146, v18
    v_mov_b32 v147, v18
    v_mov_b32 v148, v18
    v_mov_b32 v149, v18
    v_mov_b32 v150, v18
    v_mov_b32 v151, v18
    v_mov_b32 v152, v18
    v_mov_b32 v153, v18
    v_mov_b32 v154, v18
    v_mov_b32 v155, v18
    v_cvt_pk_bf16_f32 v204, v172, v173
    v_cvt_pk_bf16_f32 v205, v174, v175
    v_cvt_pk_bf16_f32 v206, v176, v177
    v_cvt_pk_bf16_f32 v207, v178, v179
    v_and_b32 v204, v204, v7
    v_and_b32 v205, v205, v7
    v_and_b32 v206, v206, v7
    v_and_b32 v207, v207, v7
    v_mov_b32 v244, v180
    v_mov_b32 v245, v181
    v_mov_b32 v246, v182
    v_mov_b32 v247, v183
    v_mfma_f32_32x32x16_bf16 v[108:123], v[36:39], v[204:207], v[140:155]
    v_mfma_f32_32x32x16_bf16 v[124:139], v[40:43], v[204:207], v[140:155]
    s_add_u32 s46, s28, 4992
    buffer_load_dwordx4 v[188:191], v3, s[4:7], s46 offen
    s_waitcnt vmcnt(0)
    s_nop 15
    s_branch L_after_6
L_fb_7:
    s_nop 15
    s_waitcnt vmcnt(0)
    s_add_u32 s46, s28, 3968
    buffer_load_dwordx4 v[188:191], v3, s[4:7], s46 offen
    s_waitcnt vmcnt(0)
    v_mfma_f32_32x32x16_bf16 v[172:187], v[12:15], v[188:191], 0
    s_nop 11
    v_cvt_pk_bf16_f32 v204, v172, v173
    v_cvt_pk_bf16_f32 v205, v174, v175
    v_cvt_pk_bf16_f32 v206, v176, v177
    v_cvt_pk_bf16_f32 v207, v178, v179
    v_and_b32 v204, v204, v7
    v_and_b32 v205, v205, v7
    v_and_b32 v206, v206, v7
    v_and_b32 v207, v207, v7
    v_mov_b32 v244, v180
    v_mov_b32 v245, v181
    v_mov_b32 v246, v182
    v_mov_b32 v247, v183
    v_mfma_f32_32x32x16_bf16 v[108:123], v[36:39], v[204:207], 0
    v_mfma_f32_32x32x16_bf16 v[124:139], v[40:43], v[204:207], 0
    v_mfma_f32_32x32x16_bf16 v[140:155], v[44:47], v[204:207], 0
    v_mfma_f32_32x32x16_bf16 v[156:171], v[48:51], v[204:207], 0
    s_nop 8
    v_max3_f32 v214, v108, v109, v110
    v_max3_f32 v215, v111, v112, v113
    v_max3_f32 v214, v214, v114, v115
    v_max3_f32 v215, v215, v116, v117
    v_max3_f32 v214, v214, v118, v119
    v_max3_f32 v215, v215, v120, v121
    v_max3_f32 v214, v214, v122, v123
    v_max3_f32 v215, v215, v124, v125
    v_max3_f32 v214, v214, v126, v127
    v_max3_f32 v215, v215, v128, v129
    v_max3_f32 v214, v214, v130, v131
    v_max3_f32 v215, v215, v132, v133
    v_max3_f32 v214, v214, v134, v135
    v_max3_f32 v215, v215, v136, v137
    v_max3_f32 v214, v214, v138, v139
    v_max3_f32 v215, v215, v140, v141
    v_max3_f32 v214, v214, v142, v143
    v_max3_f32 v215, v215, v144, v145
    v_max3_f32 v214, v214, v146, v147
    v_max3_f32 v215, v215, v148, v149
    v_max3_f32 v214, v214, v150, v151
    v_max3_f32 v215, v215, v152, v153
    v_max3_f32 v214, v214, v154, v155
    v_max3_f32 v215, v215, v156, v157
    v_max3_f32 v214, v214, v158, v159
    v_max_f32 v214, v214, v215
    v_mov_b32 v215, v214
    s_nop 1
    v_permlane32_swap_b32 v214, v215
    v_max_f32 v214, v214, v215
    v_mul_f32 v140, -1.0, v214
    v_mul_f32 v141, -1.0, v214
    v_mul_f32 v142, -1.0, v214
    v_mul_f32 v143, -1.0, v214
    v_mul_f32 v144, -1.0, v214
    v_mul_f32 v145, -1.0, v214
    v_mul_f32 v146, -1.0, v214
    v_mul_f32 v147, -1.0, v214
    v_mul_f32 v148, -1.0, v214
    v_mul_f32 v149, -1.0, v214
    v_mul_f32 v150, -1.0, v214
    v_mul_f32 v151, -1.0, v214
    v_mul_f32 v152, -1.0, v214
    v_mul_f32 v153, -1.0, v214
    v_mul_f32 v154, -1.0, v214
    v_mul_f32 v155, -1.0, v214
    s_nop 1
    v_mfma_f32_32x32x16_bf16 v[108:123], v[36:39], v[204:207], v[140:155]
    v_mfma_f32_32x32x16_bf16 v[124:139], v[40:43], v[204:207], v[140:155]
    s_nop 10
    v_exp_f32 v108, v108
    v_exp_f32 v109, v109
    v_exp_f32 v110, v110
    v_exp_f32 v111, v111
    v_exp_f32 v112, v112
    v_exp_f32 v113, v113
    v_exp_f32 v114, v114
    v_exp_f32 v115, v115
    v_cvt_pk_bf16_f32 v196, v108, v109
    v_cvt_pk_bf16_f32 v197, v110, v111
    v_cvt_pk_bf16_f32 v198, v112, v113
    v_cvt_pk_bf16_f32 v199, v114, v115
    s_nop 1
    v_mfma_f32_32x32x16_bf16 v[156:171], v[80:83], v[196:199], 0
    v_exp_f32 v116, v116
    v_exp_f32 v117, v117
    v_exp_f32 v118, v118
    v_exp_f32 v119, v119
    v_exp_f32 v120, v120
    v_exp_f32 v121, v121
    v_exp_f32 v122, v122
    v_exp_f32 v123, v123
    v_cvt_pk_bf16_f32 v200, v116, v117
    v_cvt_pk_bf16_f32 v201, v118, v119
    v_cvt_pk_bf16_f32 v202, v120, v121
    v_cvt_pk_bf16_f32 v203, v122, v123
    s_nop 1
    v_mfma_f32_32x32x16_bf16 v[156:171], v[84:87], v[200:203], v[156:171]
    v_mfma_f32_32x32x16_bf16 v[108:123], v[44:47], v[204:207], v[140:155]
    v_exp_f32 v124, v124
    v_exp_f32 v125, v125
    v_exp_f32 v126, v126
    v_exp_f32 v127, v127
    v_exp_f32 v128, v128
    v_exp_f32 v129, v129
    v_exp_f32 v130, v130
    v_exp_f32 v131, v131
    v_cvt_pk_bf16_f32 v196, v124, v125
    v_cvt_pk_bf16_f32 v197, v126, v127
    v_cvt_pk_bf16_f32 v198, v128, v129
    v_cvt_pk_bf16_f32 v199, v130, v131
    s_nop 1
    v_mfma_f32_32x32x16_bf16 v[156:171], v[88:91], v[196:199], v[156:171]
    v_exp_f32 v132, v132
    v_exp_f32 v133, v133
    v_exp_f32 v134, v134
    v_exp_f32 v135, v135
    v_exp_f32 v136, v136
    v_exp_f32 v137, v137
    v_exp_f32 v138, v138
    v_exp_f32 v139, v139
    v_cvt_pk_bf16_f32 v200, v132, v133
    v_cvt_pk_bf16_f32 v201, v134, v135
    v_cvt_pk_bf16_f32 v202, v136, v137
    v_cvt_pk_bf16_f32 v203, v138, v139
    s_nop 1
    v_mfma_f32_32x32x16_bf16 v[156:171], v[92:95], v[200:203], v[156:171]
    v_mfma_f32_32x32x16_bf16 v[124:139], v[48:51], v[204:207], v[140:155]
    v_exp_f32 v108, v108
    v_exp_f32 v109, v109
    v_exp_f32 v110, v110
    v_exp_f32 v111, v111
    v_exp_f32 v112, v112
    v_exp_f32 v113, v113
    v_exp_f32 v114, v114
    v_exp_f32 v115, v115
    v_cvt_pk_bf16_f32 v196, v108, v109
    v_cvt_pk_bf16_f32 v197, v110, v111
    v_cvt_pk_bf16_f32 v198, v112, v113
    v_cvt_pk_bf16_f32 v199, v114, v115
    s_nop 1
    v_mfma_f32_32x32x16_bf16 v[156:171], v[96:99], v[196:199], v[156:171]
    v_exp_f32 v116, v116
    v_exp_f32 v117, v117
    v_exp_f32 v118, v118
    v_exp_f32 v119, v119
    v_exp_f32 v120, v120
    v_exp_f32 v121, v121
    v_exp_f32 v122, v122
    v_exp_f32 v123, v123
    v_cvt_pk_bf16_f32 v200, v116, v117
    v_cvt_pk_bf16_f32 v201, v118, v119
    v_cvt_pk_bf16_f32 v202, v120, v121
    v_cvt_pk_bf16_f32 v203, v122, v123
    s_nop 1
    v_mfma_f32_32x32x16_bf16 v[156:171], v[100:103], v[200:203], v[156:171]
    v_exp_f32 v124, v124
    v_exp_f32 v125, v125
    v_exp_f32 v126, v126
    v_exp_f32 v127, v127
    v_cvt_pk_bf16_f32 v196, v124, v125
    v_cvt_pk_bf16_f32 v197, v126, v127
    v_mov_b32 v198, 0
    v_mov_b32 v199, 0
    s_nop 1
    v_mfma_f32_32x32x16_bf16 v[156:171], v[104:107], v[196:199], v[156:171]
    s_nop 11
    v_rcp_f32 v216, v164
    s_add_u32 s47, s28, 3968
    v_fma_f32 v212, v156, v216, v244
    v_fma_f32 v213, v157, v216, v245
    v_fma_f32 v214, v158, v216, v246
    v_fma_f32 v215, v159, v216, v247
    v_cvt_pk_bf16_f32 v212, v212, v213
    v_cvt_pk_bf16_f32 v213, v214, v215
    v_pk_max_i16 v212, v212, 0
    v_pk_max_i16 v213, v213, 0
    buffer_store_dwordx2 v[212:213], v5, s[8:11], s47 offen offset:0
    s_add_u32 s46, s28, 4992
    buffer_load_dwordx4 v[188:191], v3, s[4:7], s46 offen
    s_waitcnt vmcnt(0)
    v_mfma_f32_32x32x16_bf16 v[172:187], v[12:15], v[188:191], 0
    v_mov_b32 v140, v18
    v_mov_b32 v141, v18
    v_mov_b32 v142, v18
    v_mov_b32 v143, v18
    v_mov_b32 v144, v18
    v_mov_b32 v145, v18
    v_mov_b32 v146, v18
    v_mov_b32 v147, v18
    v_mov_b32 v148, v18
    v_mov_b32 v149, v18
    v_mov_b32 v150, v18
    v_mov_b32 v151, v18
    v_mov_b32 v152, v18
    v_mov_b32 v153, v18
    v_mov_b32 v154, v18
    v_mov_b32 v155, v18
    v_cvt_pk_bf16_f32 v192, v172, v173
    v_cvt_pk_bf16_f32 v193, v174, v175
    v_cvt_pk_bf16_f32 v194, v176, v177
    v_cvt_pk_bf16_f32 v195, v178, v179
    v_and_b32 v192, v192, v7
    v_and_b32 v193, v193, v7
    v_and_b32 v194, v194, v7
    v_and_b32 v195, v195, v7
    v_mov_b32 v208, v180
    v_mov_b32 v209, v181
    v_mov_b32 v210, v182
    v_mov_b32 v211, v183
    v_mfma_f32_32x32x16_bf16 v[108:123], v[36:39], v[192:195], v[140:155]
    v_mfma_f32_32x32x16_bf16 v[124:139], v[40:43], v[192:195], v[140:155]
    v_cmp_le_u32 s[40:41], 12, v1
    v_mov_b32 v212, 6016
    v_mov_b32 v213, 2816
    v_cndmask_b32_e64 v212, v212, v213, s[40:41]
    v_add_u32 v212, v3, v212
    buffer_load_dwordx4 v[188:191], v212, s[4:7], s28 offen
    s_waitcnt vmcnt(0)
    s_nop 15
    s_branch L_after_7
L_fb_8:
    s_nop 15
    s_waitcnt vmcnt(0)
    s_add_u32 s46, s28, 4992
    buffer_load_dwordx4 v[188:191], v3, s[4:7], s46 offen
    s_waitcnt vmcnt(0)
    v_mfma_f32_32x32x16_bf16 v[172:187], v[12:15], v[188:191], 0
    s_nop 11
    v_cvt_pk_bf16_f32 v192, v172, v173
    v_cvt_pk_bf16_f32 v193, v174, v175
    v_cvt_pk_bf16_f32 v194, v176, v177
    v_cvt_pk_bf16_f32 v195, v178, v179
    v_and_b32 v192, v192, v7
    v_and_b32 v193, v193, v7
    v_and_b32 v194, v194, v7
    v_and_b32 v195, v195, v7
    v_mov_b32 v208, v180
    v_mov_b32 v209, v181
    v_mov_b32 v210, v182
    v_mov_b32 v211, v183
    v_mfma_f32_32x32x16_bf16 v[108:123], v[36:39], v[192:195], 0
    v_mfma_f32_32x32x16_bf16 v[124:139], v[40:43], v[192:195], 0
    v_mfma_f32_32x32x16_bf16 v[140:155], v[44:47], v[192:195], 0
    v_mfma_f32_32x32x16_bf16 v[156:171], v[48:51], v[192:195], 0
    s_nop 8
    v_max3_f32 v214, v108, v109, v110
    v_max3_f32 v215, v111, v112, v113
    v_max3_f32 v214, v214, v114, v115
    v_max3_f32 v215, v215, v116, v117
    v_max3_f32 v214, v214, v118, v119
    v_max3_f32 v215, v215, v120, v121
    v_max3_f32 v214, v214, v122, v123
    v_max3_f32 v215, v215, v124, v125
    v_max3_f32 v214, v214, v126, v127
    v_max3_f32 v215, v215, v128, v129
    v_max3_f32 v214, v214, v130, v131
    v_max3_f32 v215, v215, v132, v133
    v_max3_f32 v214, v214, v134, v135
    v_max3_f32 v215, v215, v136, v137
    v_max3_f32 v214, v214, v138, v139
    v_max3_f32 v215, v215, v140, v141
    v_max3_f32 v214, v214, v142, v143
    v_max3_f32 v215, v215, v144, v145
    v_max3_f32 v214, v214, v146, v147
    v_max3_f32 v215, v215, v148, v149
    v_max3_f32 v214, v214, v150, v151
    v_max3_f32 v215, v215, v152, v153
    v_max3_f32 v214, v214, v154, v155
    v_max3_f32 v215, v215, v156, v157
    v_max3_f32 v214, v214, v158, v159
    v_max_f32 v214, v214, v215
    v_mov_b32 v215, v214
    s_nop 1
    v_permlane32_swap_b32 v214, v215
    v_max_f32 v214, v214, v215
    v_mul_f32 v140, -1.0, v214
    v_mul_f32 v141, -1.0, v214
    v_mul_f32 v142, -1.0, v214
    v_mul_f32 v143, -1.0, v214
    v_mul_f32 v144, -1.0, v214
    v_mul_f32 v145, -1.0, v214
    v_mul_f32 v146, -1.0, v214
    v_mul_f32 v147, -1.0, v214
    v_mul_f32 v148, -1.0, v214
    v_mul_f32 v149, -1.0, v214
    v_mul_f32 v150, -1.0, v214
    v_mul_f32 v151, -1.0, v214
    v_mul_f32 v152, -1.0, v214
    v_mul_f32 v153, -1.0, v214
    v_mul_f32 v154, -1.0, v214
    v_mul_f32 v155, -1.0, v214
    s_nop 1
    v_mfma_f32_32x32x16_bf16 v[108:123], v[36:39], v[192:195], v[140:155]
    v_mfma_f32_32x32x16_bf16 v[124:139], v[40:43], v[192:195], v[140:155]
    s_nop 10
    v_exp_f32 v108, v108
    v_exp_f32 v109, v109
    v_exp_f32 v110, v110
    v_exp_f32 v111, v111
    v_exp_f32 v112, v112
    v_exp_f32 v113, v113
    v_exp_f32 v114, v114
    v_exp_f32 v115, v115
    v_cvt_pk_bf16_f32 v196, v108, v109
    v_cvt_pk_bf16_f32 v197, v110, v111
    v_cvt_pk_bf16_f32 v198, v112, v113
    v_cvt_pk_bf16_f32 v199, v114, v115
    s_nop 1
    v_mfma_f32_32x32x16_bf16 v[156:171], v[80:83], v[196:199], 0
    v_exp_f32 v116, v116
    v_exp_f32 v117, v117
    v_exp_f32 v118, v118
    v_exp_f32 v119, v119
    v_exp_f32 v120, v120
    v_exp_f32 v121, v121
    v_exp_f32 v122, v122
    v_exp_f32 v123, v123
    v_cvt_pk_bf16_f32 v200, v116, v117
    v_cvt_pk_bf16_f32 v201, v118, v119
    v_cvt_pk_bf16_f32 v202, v120, v121
    v_cvt_pk_bf16_f32 v203, v122, v123
    s_nop 1
    v_mfma_f32_32x32x16_bf16 v[156:171], v[84:87], v[200:203], v[156:171]
    v_mfma_f32_32x32x16_bf16 v[108:123], v[44:47], v[192:195], v[140:155]
    v_exp_f32 v124, v124
    v_exp_f32 v125, v125
    v_exp_f32 v126, v126
    v_exp_f32 v127, v127
    v_exp_f32 v128, v128
    v_exp_f32 v129, v129
    v_exp_f32 v130, v130
    v_exp_f32 v131, v131
    v_cvt_pk_bf16_f32 v196, v124, v125
    v_cvt_pk_bf16_f32 v197, v126, v127
    v_cvt_pk_bf16_f32 v198, v128, v129
    v_cvt_pk_bf16_f32 v199, v130, v131
    s_nop 1
    v_mfma_f32_32x32x16_bf16 v[156:171], v[88:91], v[196:199], v[156:171]
    v_exp_f32 v132, v132
    v_exp_f32 v133, v133
    v_exp_f32 v134, v134
    v_exp_f32 v135, v135
    v_exp_f32 v136, v136
    v_exp_f32 v137, v137
    v_exp_f32 v138, v138
    v_exp_f32 v139, v139
    v_cvt_pk_bf16_f32 v200, v132, v133
    v_cvt_pk_bf16_f32 v201, v134, v135
    v_cvt_pk_bf16_f32 v202, v136, v137
    v_cvt_pk_bf16_f32 v203, v138, v139
    s_nop 1
    v_mfma_f32_32x32x16_bf16 v[156:171], v[92:95], v[200:203], v[156:171]
    v_mfma_f32_32x32x16_bf16 v[124:139], v[48:51], v[192:195], v[140:155]
    v_exp_f32 v108, v108
    v_exp_f32 v109, v109
    v_exp_f32 v110, v110
    v_exp_f32 v111, v111
    v_exp_f32 v112, v112
    v_exp_f32 v113, v113
    v_exp_f32 v114, v114
    v_exp_f32 v115, v115
    v_cvt_pk_bf16_f32 v196, v108, v109
    v_cvt_pk_bf16_f32 v197, v110, v111
    v_cvt_pk_bf16_f32 v198, v112, v113
    v_cvt_pk_bf16_f32 v199, v114, v115
    s_nop 1
    v_mfma_f32_32x32x16_bf16 v[156:171], v[96:99], v[196:199], v[156:171]
    v_exp_f32 v116, v116
    v_exp_f32 v117, v117
    v_exp_f32 v118, v118
    v_exp_f32 v119, v119
    v_exp_f32 v120, v120
    v_exp_f32 v121, v121
    v_exp_f32 v122, v122
    v_exp_f32 v123, v123
    v_cvt_pk_bf16_f32 v200, v116, v117
    v_cvt_pk_bf16_f32 v201, v118, v119
    v_cvt_pk_bf16_f32 v202, v120, v121
    v_cvt_pk_bf16_f32 v203, v122, v123
    s_nop 1
    v_mfma_f32_32x32x16_bf16 v[156:171], v[100:103], v[200:203], v[156:171]
    v_exp_f32 v124, v124
    v_exp_f32 v125, v125
    v_exp_f32 v126, v126
    v_exp_f32 v127, v127
    v_cvt_pk_bf16_f32 v196, v124, v125
    v_cvt_pk_bf16_f32 v197, v126, v127
    v_mov_b32 v198, 0
    v_mov_b32 v199, 0
    s_nop 1
    v_mfma_f32_32x32x16_bf16 v[156:171], v[104:107], v[196:199], v[156:171]
    s_nop 11
    v_rcp_f32 v216, v164
    s_add_u32 s47, s28, 4992
    v_fma_f32 v212, v156, v216, v208
    v_fma_f32 v213, v157, v216, v209
    v_fma_f32 v214, v158, v216, v210
    v_fma_f32 v215, v159, v216, v211
    v_cvt_pk_bf16_f32 v212, v212, v213
    v_cvt_pk_bf16_f32 v213, v214, v215
    v_pk_max_i16 v212, v212, 0
    v_pk_max_i16 v213, v213, 0
    buffer_store_dwordx2 v[212:213], v5, s[8:11], s47 offen offset:0
    v_cmp_le_u32 s[40:41], 12, v1
    v_mov_b32 v212, 6016
    v_mov_b32 v213, 2816
    v_cndmask_b32_e64 v212, v212, v213, s[40:41]
    v_add_u32 v212, v3, v212
    buffer_load_dwordx4 v[188:191], v212, s[4:7], s28 offen
    s_waitcnt vmcnt(0)
    v_cmp_le_u32 s[38:39], 12, v1
    v_mfma_f32_32x32x16_bf16 v[172:187], v[12:15], v[188:191], 0
    s_nop 0
    v_cndmask_b32_e64 v216, v18, v19, s[38:39]
    v_mov_b32 v140, v216
    v_mov_b32 v141, v216
    v_mov_b32 v142, v216
    v_mov_b32 v143, v216
    v_mov_b32 v144, v216
    v_mov_b32 v145, v216
    v_mov_b32 v146, v216
    v_mov_b32 v147, v216
    v_mov_b32 v148, v216
    v_mov_b32 v149, v216
    v_mov_b32 v150, v216
    v_mov_b32 v151, v216
    v_mov_b32 v152, v216
    v_mov_b32 v153, v216
    v_mov_b32 v154, v216
    v_mov_b32 v155, v216
    v_cvt_pk_bf16_f32 v204, v172, v173
    v_cvt_pk_bf16_f32 v205, v174, v175
    v_cvt_pk_bf16_f32 v206, v176, v177
    v_cvt_pk_bf16_f32 v207, v178, v179
    v_cndmask_b32_e64 v217, v7, v8, s[38:39]
    v_and_b32 v204, v204, v217
    v_and_b32 v205, v205, v217
    v_and_b32 v206, v206, v217
    v_and_b32 v207, v207, v217
    v_cndmask_b32_e64 v244, v180, v184, s[38:39]
    v_cndmask_b32_e64 v245, v181, v185, s[38:39]
    v_cndmask_b32_e64 v246, v182, v186, s[38:39]
    v_cndmask_b32_e64 v247, v183, v187, s[38:39]
    v_mfma_f32_32x32x16_bf16 v[108:123], v[36:39], v[204:207], v[140:155]
    v_mfma_f32_32x32x16_bf16 v[124:139], v[40:43], v[204:207], v[140:155]
    s_add_u32 s46, s28, 3840
    buffer_load_dwordx4 v[188:191], v3, s[4:7], s46 offen
    s_waitcnt vmcnt(0)
    s_nop 15
    s_branch L_after_8
L_fb_9:
    s_nop 15
    s_waitcnt vmcnt(0)
    v_cmp_le_u32 s[40:41], 12, v1
    v_mov_b32 v212, 6016
    v_mov_b32 v213, 2816
    v_cndmask_b32_e64 v212, v212, v213, s[40:41]
    v_add_u32 v212, v3, v212
    buffer_load_dwordx4 v[188:191], v212, s[4:7], s28 offen
    s_waitcnt vmcnt(0)
    v_cmp_le_u32 s[38:39], 12, v1
    v_mfma_f32_32x32x16_bf16 v[172:187], v[12:15], v[188:191], 0
    s_nop 11
    v_cvt_pk_bf16_f32 v204, v172, v173
    v_cvt_pk_bf16_f32 v205, v174, v175
    v_cvt_pk_bf16_f32 v206, v176, v177
    v_cvt_pk_bf16_f32 v207, v178, v179
    v_cndmask_b32_e64 v217, v7, v8, s[38:39]
    v_and_b32 v204, v204, v217
    v_and_b32 v205, v205, v217
    v_and_b32 v206, v206, v217
    v_and_b32 v207, v207, v217
    v_cndmask_b32_e64 v244, v180, v184, s[38:39]
    v_cndmask_b32_e64 v245, v181, v185, s[38:39]
    v_cndmask_b32_e64 v246, v182, v186, s[38:39]
    v_cndmask_b32_e64 v247, v183, v187, s[38:39]
    v_mfma_f32_32x32x16_bf16 v[108:123], v[36:39], v[204:207], 0
    v_mfma_f32_32x32x16_bf16 v[124:139], v[40:43], v[204:207], 0
    v_mfma_f32_32x32x16_bf16 v[140:155], v[44:47], v[204:207], 0
    v_mfma_f32_32x32x16_bf16 v[156:171], v[48:51], v[204:207], 0
    s_nop 8
    v_max3_f32 v214, v108, v109, v110
    v_max3_f32 v215, v111, v112, v113
    v_max3_f32 v214, v214, v114, v115
    v_max3_f32 v215, v215, v116, v117
    v_max3_f32 v214, v214, v118, v119
    v_max3_f32 v215, v215, v120, v121
    v_max3_f32 v214, v214, v122, v123
    v_max3_f32 v215, v215, v124, v125
    v_max3_f32 v214, v214, v126, v127
    v_max3_f32 v215, v215, v128, v129
    v_max3_f32 v214, v214, v130, v131
    v_max3_f32 v215, v215, v132, v133
    v_max3_f32 v214, v214, v134, v135
    v_max3_f32 v215, v215, v136, v137
    v_max3_f32 v214, v214, v138, v139
    v_max3_f32 v215, v215, v140, v141
    v_max3_f32 v214, v214, v142, v143
    v_max3_f32 v215, v215, v144, v145
    v_max3_f32 v214, v214, v146, v147
    v_max3_f32 v215, v215, v148, v149
    v_max3_f32 v214, v214, v150, v151
    v_max3_f32 v215, v215, v152, v153
    v_max3_f32 v214, v214, v154, v155
    v_max3_f32 v215, v215, v156, v157
    v_max3_f32 v214, v214, v158, v159
    v_max_f32 v214, v214, v215
    v_mov_b32 v215, v214
    s_nop 1
    v_permlane32_swap_b32 v214, v215
    v_max_f32 v214, v214, v215
    v_mul_f32 v140, -1.0, v214
    v_mul_f32 v141, -1.0, v214
    v_mul_f32 v142, -1.0, v214
    v_mul_f32 v143, -1.0, v214
    v_mul_f32 v144, -1.0, v214
    v_mul_f32 v145, -1.0, v214
    v_mul_f32 v146, -1.0, v214
    v_mul_f32 v147, -1.0, v214
    v_mul_f32 v148, -1.0, v214
    v_mul_f32 v149, -1.0, v214
    v_mul_f32 v150, -1.0, v214
    v_mul_f32 v151, -1.0, v214
    v_mul_f32 v152, -1.0, v214
    v_mul_f32 v153, -1.0, v214
    v_mul_f32 v154, -1.0, v214
    v_mul_f32 v155, -1.0, v214
    s_nop 1
    v_mfma_f32_32x32x16_bf16 v[108:123], v[36:39], v[204:207], v[140:155]
    v_mfma_f32_32x32x16_bf16 v[124:139], v[40:43], v[204:207], v[140:155]
    s_nop 10
    v_exp_f32 v108, v108
    v_exp_f32 v109, v109
    v_exp_f32 v110, v110
    v_exp_f32 v111, v111
    v_exp_f32 v112, v112
    v_exp_f32 v113, v113
    v_exp_f32 v114, v114
    v_exp_f32 v115, v115
    v_cvt_pk_bf16_f32 v196, v108, v109
    v_cvt_pk_bf16_f32 v197, v110, v111
    v_cvt_pk_bf16_f32 v198, v112, v113
    v_cvt_pk_bf16_f32 v199, v114, v115
    s_nop 1
    v_mfma_f32_32x32x16_bf16 v[156:171], v[80:83], v[196:199], 0
    v_exp_f32 v116, v116
    v_exp_f32 v117, v117
    v_exp_f32 v118, v118
    v_exp_f32 v119, v119
    v_exp_f32 v120, v120
    v_exp_f32 v121, v121
    v_exp_f32 v122, v122
    v_exp_f32 v123, v123
    v_cvt_pk_bf16_f32 v200, v116, v117
    v_cvt_pk_bf16_f32 v201, v118, v119
    v_cvt_pk_bf16_f32 v202, v120, v121
    v_cvt_pk_bf16_f32 v203, v122, v123
    s_nop 1
    v_mfma_f32_32x32x16_bf16 v[156:171], v[84:87], v[200:203], v[156:171]
    v_mfma_f32_32x32x16_bf16 v[108:123], v[44:47], v[204:207], v[140:155]
    v_exp_f32 v124, v124
    v_exp_f32 v125, v125
    v_exp_f32 v126, v126
    v_exp_f32 v127, v127
    v_exp_f32 v128, v128
    v_exp_f32 v129, v129
    v_exp_f32 v130, v130
    v_exp_f32 v131, v131
    v_cvt_pk_bf16_f32 v196, v124, v125
    v_cvt_pk_bf16_f32 v197, v126, v127
    v_cvt_pk_bf16_f32 v198, v128, v129
    v_cvt_pk_bf16_f32 v199, v130, v131
    s_nop 1
    v_mfma_f32_32x32x16_bf16 v[156:171], v[88:91], v[196:199], v[156:171]
    v_exp_f32 v132, v132
    v_exp_f32 v133, v133
    v_exp_f32 v134, v134
    v_exp_f32 v135, v135
    v_exp_f32 v136, v136
    v_exp_f32 v137, v137
    v_exp_f32 v138, v138
    v_exp_f32 v139, v139
    v_cvt_pk_bf16_f32 v200, v132, v133
    v_cvt_pk_bf16_f32 v201, v134, v135
    v_cvt_pk_bf16_f32 v202, v136, v137
    v_cvt_pk_bf16_f32 v203, v138, v139
    s_nop 1
    v_mfma_f32_32x32x16_bf16 v[156:171], v[92:95], v[200:203], v[156:171]
    v_mfma_f32_32x32x16_bf16 v[124:139], v[48:51], v[204:207], v[140:155]
    v_exp_f32 v108, v108
    v_exp_f32 v109, v109
    v_exp_f32 v110, v110
    v_exp_f32 v111, v111
    v_exp_f32 v112, v112
    v_exp_f32 v113, v113
    v_exp_f32 v114, v114
    v_exp_f32 v115, v115
    v_cvt_pk_bf16_f32 v196, v108, v109
    v_cvt_pk_bf16_f32 v197, v110, v111
    v_cvt_pk_bf16_f32 v198, v112, v113
    v_cvt_pk_bf16_f32 v199, v114, v115
    s_nop 1
    v_mfma_f32_32x32x16_bf16 v[156:171], v[96:99], v[196:199], v[156:171]
    v_exp_f32 v116, v116
    v_exp_f32 v117, v117
    v_exp_f32 v118, v118
    v_exp_f32 v119, v119
    v_exp_f32 v120, v120
    v_exp_f32 v121, v121
    v_exp_f32 v122, v122
    v_exp_f32 v123, v123
    v_cvt_pk_bf16_f32 v200, v116, v117
    v_cvt_pk_bf16_f32 v201, v118, v119
    v_cvt_pk_bf16_f32 v202, v120, v121
    v_cvt_pk_bf16_f32 v203, v122, v123
    s_nop 1
    v_mfma_f32_32x32x16_bf16 v[156:171], v[100:103], v[200:203], v[156:171]
    v_exp_f32 v124, v124
    v_exp_f32 v125, v125
    v_exp_f32 v126, v126
    v_exp_f32 v127, v127
    v_cvt_pk_bf16_f32 v196, v124, v125
    v_cvt_pk_bf16_f32 v197, v126, v127
    v_mov_b32 v198, 0
    v_mov_b32 v199, 0
    s_nop 1
    v_mfma_f32_32x32x16_bf16 v[156:171], v[104:107], v[196:199], v[156:171]
    s_nop 11
    v_rcp_f32 v216, v164
    v_cndmask_b32_e64 v212, v156, v160, s[38:39]
    v_cndmask_b32_e64 v213, v157, v161, s[38:39]
    v_cndmask_b32_e64 v214, v158, v162, s[38:39]
    v_cndmask_b32_e64 v215, v159, v163, s[38:39]
    v_mov_b32 v217, 6016
    v_mov_b32 v218, 0xb10
    v_cndmask_b32_e64 v217, v217, v218, s[38:39]
    v_add_u32 v217, v5, v217
    v_fma_f32 v212, v212, v216, v244
    v_fma_f32 v213, v213, v216, v245
    v_fma_f32 v214, v214, v216, v246
    v_fma_f32 v215, v215, v216, v247
    v_cvt_pk_bf16_f32 v212, v212, v213
    v_cvt_pk_bf16_f32 v213, v214, v215
    v_pk_max_i16 v212, v212, 0
    v_pk_max_i16 v213, v213, 0
    buffer_store_dwordx2 v[212:213], v217, s[8:11], s28 offen offset:0
    s_add_u32 s46, s28, 3840
    buffer_load_dwordx4 v[188:191], v3, s[4:7], s46 offen
    s_waitcnt vmcnt(0)
    v_mfma_f32_32x32x16_bf16 v[172:187], v[12:15], v[188:191], 0
    v_mov_b32 v140, v19
    v_mov_b32 v141, v19
    v_mov_b32 v142, v19
    v_mov_b32 v143, v19
    v_mov_b32 v144, v19
    v_mov_b32 v145, v19
    v_mov_b32 v146, v19
    v_mov_b32 v147, v19
    v_mov_b32 v148, v19
    v_mov_b32 v149, v19
    v_mov_b32 v150, v19
    v_mov_b32 v151, v19
    v_mov_b32 v152, v19
    v_mov_b32 v153, v19
    v_mov_b32 v154, v19
    v_mov_b32 v155, v19
    v_cvt_pk_bf16_f32 v192, v172, v173
    v_cvt_pk_bf16_f32 v193, v174, v175
    v_cvt_pk_bf16_f32 v194, v176, v177
    v_cvt_pk_bf16_f32 v195, v178, v179
    v_and_b32 v192, v192, v8
    v_and_b32 v193, v193, v8
    v_and_b32 v194, v194, v8
    v_and_b32 v195, v195, v8
    v_mov_b32 v208, v184
    v_mov_b32 v209, v185
    v_mov_b32 v210, v186
    v_mov_b32 v211, v187
    v_mfma_f32_32x32x16_bf16 v[108:123], v[36:39], v[192:195], v[140:155]
    v_mfma_f32_32x32x16_bf16 v[124:139], v[40:43], v[192:195], v[140:155]
    s_add_u32 s46, s28, 4864
    buffer_load_dwordx4 v[188:191], v3, s[4:7], s46 offen
    s_waitcnt vmcnt(0)
    s_nop 15
    s_branch L_after_9
L_fb_10:
    s_nop 15
    s_waitcnt vmcnt(0)
    s_add_u32 s46, s28, 3840
    buffer_load_dwordx4 v[188:191], v3, s[4:7], s46 offen
    s_waitcnt vmcnt(0)
    v_mfma_f32_32x32x16_bf16 v[172:187], v[12:15], v[188:191], 0
    s_nop 11
    v_cvt_pk_bf16_f32 v192, v172, v173
    v_cvt_pk_bf16_f32 v193, v174, v175
    v_cvt_pk_bf16_f32 v194, v176, v177
    v_cvt_pk_bf16_f32 v195, v178, v179
    v_and_b32 v192, v192, v8
    v_and_b32 v193, v193, v8
    v_and_b32 v194, v194, v8
    v_and_b32 v195, v195, v8
    v_mov_b32 v208, v184
    v_mov_b32 v209, v185
    v_mov_b32 v210, v186
    v_mov_b32 v211, v187
    v_mfma_f32_32x32x16_bf16 v[108:123], v[36:39], v[192:195], 0
    v_mfma_f32_32x32x16_bf16 v[124:139], v[40:43], v[192:195], 0
    v_mfma_f32_32x32x16_bf16 v[140:155], v[44:47], v[192:195], 0
    v_mfma_f32_32x32x16_bf16 v[156:171], v[48:51], v[192:195], 0
    s_nop 8
    v_max3_f32 v214, v108, v109, v110
    v_max3_f32 v215, v111, v112, v113
    v_max3_f32 v214, v214, v114, v115
    v_max3_f32 v215, v215, v116, v117
    v_max3_f32 v214, v214, v118, v119
    v_max3_f32 v215, v215, v120, v121
    v_max3_f32 v214, v214, v122, v123
    v_max3_f32 v215, v215, v124, v125
    v_max3_f32 v214, v214, v126, v127
    v_max3_f32 v215, v215, v128, v129
    v_max3_f32 v214, v214, v130, v131
    v_max3_f32 v215, v215, v132, v133
    v_max3_f32 v214, v214, v134, v135
    v_max3_f32 v215, v215, v136, v137
    v_max3_f32 v214, v214, v138, v139
    v_max3_f32 v215, v215, v140, v141
    v_max3_f32 v214, v214, v142, v143
    v_max3_f32 v215, v215, v144, v145
    v_max3_f32 v214, v214, v146, v147
    v_max3_f32 v215, v215, v148, v149
    v_max3_f32 v214, v214, v150, v151
    v_max3_f32 v215, v215, v152, v153
    v_max3_f32 v214, v214, v154, v155
    v_max3_f32 v215, v215, v156, v157
    v_max3_f32 v214, v214, v158, v159
    v_max_f32 v214, v214, v215
    v_mov_b32 v215, v214
    s_nop 1
    v_permlane32_swap_b32 v214, v215
    v_max_f32 v214, v214, v215
    v_mul_f32 v140, -1.0, v214
    v_mul_f32 v141, -1.0, v214
    v_mul_f32 v142, -1.0, v214
    v_mul_f32 v143, -1.0, v214
    v_mul_f32 v144, -1.0, v214
    v_mul_f32 v145, -1.0, v214
    v_mul_f32 v146, -1.0, v214
    v_mul_f32 v147, -1.0, v214
    v_mul_f32 v148, -1.0, v214
    v_mul_f32 v149, -1.0, v214
    v_mul_f32 v150, -1.0, v214
    v_mul_f32 v151, -1.0, v214
    v_mul_f32 v152, -1.0, v214
    v_mul_f32 v153, -1.0, v214
    v_mul_f32 v154, -1.0, v214
    v_mul_f32 v155, -1.0, v214
    s_nop 1
    v_mfma_f32_32x32x16_bf16 v[108:123], v[36:39], v[192:195], v[140:155]
    v_mfma_f32_32x32x16_bf16 v[124:139], v[40:43], v[192:195], v[140:155]
    s_nop 10
    v_exp_f32 v108, v108
    v_exp_f32 v109, v109
    v_exp_f32 v110, v110
    v_exp_f32 v111, v111
    v_exp_f32 v112, v112
    v_exp_f32 v113, v113
    v_exp_f32 v114, v114
    v_exp_f32 v115, v115
    v_cvt_pk_bf16_f32 v196, v108, v109
    v_cvt_pk_bf16_f32 v197, v110, v111
    v_cvt_pk_bf16_f32 v198, v112, v113
    v_cvt_pk_bf16_f32 v199, v114, v115
    s_nop 1
    v_mfma_f32_32x32x16_bf16 v[156:171], v[80:83], v[196:199], 0
    v_exp_f32 v116, v116
    v_exp_f32 v117, v117
    v_exp_f32 v118, v118
    v_exp_f32 v119, v119
    v_exp_f32 v120, v120
    v_exp_f32 v121, v121
    v_exp_f32 v122, v122
    v_exp_f32 v123, v123
    v_cvt_pk_bf16_f32 v200, v116, v117
    v_cvt_pk_bf16_f32 v201, v118, v119
    v_cvt_pk_bf16_f32 v202, v120, v121
    v_cvt_pk_bf16_f32 v203, v122, v123
    s_nop 1
    v_mfma_f32_32x32x16_bf16 v[156:171], v[84:87], v[200:203], v[156:171]
    v_mfma_f32_32x32x16_bf16 v[108:123], v[44:47], v[192:195], v[140:155]
    v_exp_f32 v124, v124
    v_exp_f32 v125, v125
    v_exp_f32 v126, v126
    v_exp_f32 v127, v127
    v_exp_f32 v128, v128
    v_exp_f32 v129, v129
    v_exp_f32 v130, v130
    v_exp_f32 v131, v131
    v_cvt_pk_bf16_f32 v196, v124, v125
    v_cvt_pk_bf16_f32 v197, v126, v127
    v_cvt_pk_bf16_f32 v198, v128, v129
    v_cvt_pk_bf16_f32 v199, v130, v131
    s_nop 1
    v_mfma_f32_32x32x16_bf16 v[156:171], v[88:91], v[196:199], v[156:171]
    v_exp_f32 v132, v132
    v_exp_f32 v133, v133
    v_exp_f32 v134, v134
    v_exp_f32 v135, v135
    v_exp_f32 v136, v136
    v_exp_f32 v137, v137
    v_exp_f32 v138, v138
    v_exp_f32 v139, v139
    v_cvt_pk_bf16_f32 v200, v132, v133
    v_cvt_pk_bf16_f32 v201, v134, v135
    v_cvt_pk_bf16_f32 v202, v136, v137
    v_cvt_pk_bf16_f32 v203, v138, v139
    s_nop 1
    v_mfma_f32_32x32x16_bf16 v[156:171], v[92:95], v[200:203], v[156:171]
    v_mfma_f32_32x32x16_bf16 v[124:139], v[48:51], v[192:195], v[140:155]
    v_exp_f32 v108, v108
    v_exp_f32 v109, v109
    v_exp_f32 v110, v110
    v_exp_f32 v111, v111
    v_exp_f32 v112, v112
    v_exp_f32 v113, v113
    v_exp_f32 v114, v114
    v_exp_f32 v115, v115
    v_cvt_pk_bf16_f32 v196, v108, v109
    v_cvt_pk_bf16_f32 v197, v110, v111
    v_cvt_pk_bf16_f32 v198, v112, v113
    v_cvt_pk_bf16_f32 v199, v114, v115
    s_nop 1
    v_mfma_f32_32x32x16_bf16 v[156:171], v[96:99], v[196:199], v[156:171]
    v_exp_f32 v116, v116
    v_exp_f32 v117, v117
    v_exp_f32 v118, v118
    v_exp_f32 v119, v119
    v_exp_f32 v120, v120
    v_exp_f32 v121, v121
    v_exp_f32 v122, v122
    v_exp_f32 v123, v123
    v_cvt_pk_bf16_f32 v200, v116, v117
    v_cvt_pk_bf16_f32 v201, v118, v119
    v_cvt_pk_bf16_f32 v202, v120, v121
    v_cvt_pk_bf16_f32 v203, v122, v123
    s_nop 1
    v_mfma_f32_32x32x16_bf16 v[156:171], v[100:103], v[200:203], v[156:171]
    v_exp_f32 v124, v124
    v_exp_f32 v125, v125
    v_exp_f32 v126, v126
    v_exp_f32 v127, v127
    v_cvt_pk_bf16_f32 v196, v124, v125
    v_cvt_pk_bf16_f32 v197, v126, v127
    v_mov_b32 v198, 0
    v_mov_b32 v199, 0
    s_nop 1
    v_mfma_f32_32x32x16_bf16 v[156:171], v[104:107], v[196:199], v[156:171]
    s_nop 11
    v_rcp_f32 v216, v164
    s_add_u32 s47, s28, 3840
    v_fma_f32 v212, v160, v216, v208
    v_fma_f32 v213, v161, v216, v209
    v_fma_f32 v214, v162, v216, v210
    v_fma_f32 v215, v163, v216, v211
    v_cvt_pk_bf16_f32 v212, v212, v213
    v_cvt_pk_bf16_f32 v213, v214, v215
    v_pk_max_i16 v212, v212, 0
    v_pk_max_i16 v213, v213, 0
    buffer_store_dwordx2 v[212:213], v5, s[8:11], s47 offen offset:16
    s_add_u32 s46, s28, 4864
    buffer_load_dwordx4 v[188:191], v3, s[4:7], s46 offen
    s_waitcnt vmcnt(0)
    v_mfma_f32_32x32x16_bf16 v[172:187], v[12:15], v[188:191], 0
    v_mov_b32 v140, v19
    v_mov_b32 v141, v19
    v_mov_b32 v142, v19
    v_mov_b32 v143, v19
    v_mov_b32 v144, v19
    v_mov_b32 v145, v19
    v_mov_b32 v146, v19
    v_mov_b32 v147, v19
    v_mov_b32 v148, v19
    v_mov_b32 v149, v19
    v_mov_b32 v150, v19
    v_mov_b32 v151, v19
    v_mov_b32 v152, v19
    v_mov_b32 v153, v19
    v_mov_b32 v154, v19
    v_mov_b32 v155, v19
    v_cvt_pk_bf16_f32 v204, v172, v173
    v_cvt_pk_bf16_f32 v205, v174, v175
    v_cvt_pk_bf16_f32 v206, v176, v177
    v_cvt_pk_bf16_f32 v207, v178, v179
    v_and_b32 v204, v204, v8
    v_and_b32 v205, v205, v8
    v_and_b32 v206, v206, v8
    v_and_b32 v207, v207, v8
    v_mov_b32 v244, v184
    v_mov_b32 v245, v185
    v_mov_b32 v246, v186
    v_mov_b32 v247, v187
    v_mfma_f32_32x32x16_bf16 v[108:123], v[36:39], v[204:207], v[140:155]
    v_mfma_f32_32x32x16_bf16 v[124:139], v[40:43], v[204:207], v[140:155]
    s_add_u32 s46, s28, 5888
    buffer_load_dwordx4 v[188:191], v3, s[4:7], s46 offen
    s_waitcnt vmcnt(0)
    s_nop 15
    s_branch L_after_10
L_fb_11:
    s_nop 15
    s_waitcnt vmcnt(0)
    s_add_u32 s46, s28, 4864
    buffer_load_dwordx4 v[188:191], v3, s[4:7], s46 offen
    s_waitcnt vmcnt(0)
    v_mfma_f32_32x32x16_bf16 v[172:187], v[12:15], v[188:191], 0
    s_nop 11
    v_cvt_pk_bf16_f32 v204, v172, v173
    v_cvt_pk_bf16_f32 v205, v174, v175
    v_cvt_pk_bf16_f32 v206, v176, v177
    v_cvt_pk_bf16_f32 v207, v178, v179
    v_and_b32 v204, v204, v8
    v_and_b32 v205, v205, v8
    v_and_b32 v206, v206, v8
    v_and_b32 v207, v207, v8
    v_mov_b32 v244, v184
    v_mov_b32 v245, v185
    v_mov_b32 v246, v186
    v_mov_b32 v247, v187
    v_mfma_f32_32x32x16_bf16 v[108:123], v[36:39], v[204:207], 0
    v_mfma_f32_32x32x16_bf16 v[124:139], v[40:43], v[204:207], 0
    v_mfma_f32_32x32x16_bf16 v[140:155], v[44:47], v[204:207], 0
    v_mfma_f32_32x32x16_bf16 v[156:171], v[48:51], v[204:207], 0
    s_nop 8
    v_max3_f32 v214, v108, v109, v110
    v_max3_f32 v215, v111, v112, v113
    v_max3_f32 v214, v214, v114, v115
    v_max3_f32 v215, v215, v116, v117
    v_max3_f32 v214, v214, v118, v119
    v_max3_f32 v215, v215, v120, v121
    v_max3_f32 v214, v214, v122, v123
    v_max3_f32 v215, v215, v124, v125
    v_max3_f32 v214, v214, v126, v127
    v_max3_f32 v215, v215, v128, v129
    v_max3_f32 v214, v214, v130, v131
    v_max3_f32 v215, v215, v132, v133
    v_max3_f32 v214, v214, v134, v135
    v_max3_f32 v215, v215, v136, v137
    v_max3_f32 v214, v214, v138, v139
    v_max3_f32 v215, v215, v140, v141
    v_max3_f32 v214, v214, v142, v143
    v_max3_f32 v215, v215, v144, v145
    v_max3_f32 v214, v214, v146, v147
    v_max3_f32 v215, v215, v148, v149
    v_max3_f32 v214, v214, v150, v151
    v_max3_f32 v215, v215, v152, v153
    v_max3_f32 v214, v214, v154, v155
    v_max3_f32 v215, v215, v156, v157
    v_max3_f32 v214, v214, v158, v159
    v_max_f32 v214, v214, v215
    v_mov_b32 v215, v214
    s_nop 1
    v_permlane32_swap_b32 v214, v215
    v_max_f32 v214, v214, v215
    v_mul_f32 v140, -1.0, v214
    v_mul_f32 v141, -1.0, v214
    v_mul_f32 v142, -1.0, v214
    v_mul_f32 v143, -1.0, v214
    v_mul_f32 v144, -1.0, v214
    v_mul_f32 v145, -1.0, v214
    v_mul_f32 v146, -1.0, v214
    v_mul_f32 v147, -1.0, v214
    v_mul_f32 v148, -1.0, v214
    v_mul_f32 v149, -1.0, v214
    v_mul_f32 v150, -1.0, v214
    v_mul_f32 v151, -1.0, v214
    v_mul_f32 v152, -1.0, v214
    v_mul_f32 v153, -1.0, v214
    v_mul_f32 v154, -1.0, v214
    v_mul_f32 v155, -1.0, v214
    s_nop 1
    v_mfma_f32_32x32x16_bf16 v[108:123], v[36:39], v[204:207], v[140:155]
    v_mfma_f32_32x32x16_bf16 v[124:139], v[40:43], v[204:207], v[140:155]
    s_nop 10
    v_exp_f32 v108, v108
    v_exp_f32 v109, v109
    v_exp_f32 v110, v110
    v_exp_f32 v111, v111
    v_exp_f32 v112, v112
    v_exp_f32 v113, v113
    v_exp_f32 v114, v114
    v_exp_f32 v115, v115
    v_cvt_pk_bf16_f32 v196, v108, v109
    v_cvt_pk_bf16_f32 v197, v110, v111
    v_cvt_pk_bf16_f32 v198, v112, v113
    v_cvt_pk_bf16_f32 v199, v114, v115
    s_nop 1
    v_mfma_f32_32x32x16_bf16 v[156:171], v[80:83], v[196:199], 0
    v_exp_f32 v116, v116
    v_exp_f32 v117, v117
    v_exp_f32 v118, v118
    v_exp_f32 v119, v119
    v_exp_f32 v120, v120
    v_exp_f32 v121, v121
    v_exp_f32 v122, v122
    v_exp_f32 v123, v123
    v_cvt_pk_bf16_f32 v200, v116, v117
    v_cvt_pk_bf16_f32 v201, v118, v119
    v_cvt_pk_bf16_f32 v202, v120, v121
    v_cvt_pk_bf16_f32 v203, v122, v123
    s_nop 1
    v_mfma_f32_32x32x16_bf16 v[156:171], v[84:87], v[200:203], v[156:171]
    v_mfma_f32_32x32x16_bf16 v[108:123], v[44:47], v[204:207], v[140:155]
    v_exp_f32 v124, v124
    v_exp_f32 v125, v125
    v_exp_f32 v126, v126
    v_exp_f32 v127, v127
    v_exp_f32 v128, v128
    v_exp_f32 v129, v129
    v_exp_f32 v130, v130
    v_exp_f32 v131, v131
    v_cvt_pk_bf16_f32 v196, v124, v125
    v_cvt_pk_bf16_f32 v197, v126, v127
    v_cvt_pk_bf16_f32 v198, v128, v129
    v_cvt_pk_bf16_f32 v199, v130, v131
    s_nop 1
    v_mfma_f32_32x32x16_bf16 v[156:171], v[88:91], v[196:199], v[156:171]
    v_exp_f32 v132, v132
    v_exp_f32 v133, v133
    v_exp_f32 v134, v134
    v_exp_f32 v135, v135
    v_exp_f32 v136, v136
    v_exp_f32 v137, v137
    v_exp_f32 v138, v138
    v_exp_f32 v139, v139
    v_cvt_pk_bf16_f32 v200, v132, v133
    v_cvt_pk_bf16_f32 v201, v134, v135
    v_cvt_pk_bf16_f32 v202, v136, v137
    v_cvt_pk_bf16_f32 v203, v138, v139
    s_nop 1
    v_mfma_f32_32x32x16_bf16 v[156:171], v[92:95], v[200:203], v[156:171]
    v_mfma_f32_32x32x16_bf16 v[124:139], v[48:51], v[204:207], v[140:155]
    v_exp_f32 v108, v108
    v_exp_f32 v109, v109
    v_exp_f32 v110, v110
    v_exp_f32 v111, v111
    v_exp_f32 v112, v112
    v_exp_f32 v113, v113
    v_exp_f32 v114, v114
    v_exp_f32 v115, v115
    v_cvt_pk_bf16_f32 v196, v108, v109
    v_cvt_pk_bf16_f32 v197, v110, v111
    v_cvt_pk_bf16_f32 v198, v112, v113
    v_cvt_pk_bf16_f32 v199, v114, v115
    s_nop 1
    v_mfma_f32_32x32x16_bf16 v[156:171], v[96:99], v[196:199], v[156:171]
    v_exp_f32 v116, v116
    v_exp_f32 v117, v117
    v_exp_f32 v118, v118
    v_exp_f32 v119, v119
    v_exp_f32 v120, v120
    v_exp_f32 v121, v121
    v_exp_f32 v122, v122
    v_exp_f32 v123, v123
    v_cvt_pk_bf16_f32 v200, v116, v117
    v_cvt_pk_bf16_f32 v201, v118, v119
    v_cvt_pk_bf16_f32 v202, v120, v121
    v_cvt_pk_bf16_f32 v203, v122, v123
    s_nop 1
    v_mfma_f32_32x32x16_bf16 v[156:171], v[100:103], v[200:203], v[156:171]
    v_exp_f32 v124, v124
    v_exp_f32 v125, v125
    v_exp_f32 v126, v126
    v_exp_f32 v127, v127
    v_cvt_pk_bf16_f32 v196, v124, v125
    v_cvt_pk_bf16_f32 v197, v126, v127
    v_mov_b32 v198, 0
    v_mov_b32 v199, 0
    s_nop 1
    v_mfma_f32_32x32x16_bf16 v[156:171], v[104:107], v[196:199], v[156:171]
    s_nop 11
    v_rcp_f32 v216, v164
    s_add_u32 s47, s28, 4864
    v_fma_f32 v212, v160, v216, v244
    v_fma_f32 v213, v161, v216, v245
    v_fma_f32 v214, v162, v216, v246
    v_fma_f32 v215, v163, v216, v247
    v_cvt_pk_bf16_f32 v212, v212, v213
    v_cvt_pk_bf16_f32 v213, v214, v215
    v_pk_max_i16 v212, v212, 0
    v_pk_max_i16 v213, v213, 0
    buffer_store_dwordx2 v[212:213], v5, s[8:11], s47 offen offset:16
    s_add_u32 s46, s28, 5888
    buffer_load_dwordx4 v[188:191], v3, s[4:7], s46 offen
    s_waitcnt vmcnt(0)
    v_cmp_le_u32 s[38:39], 16, v1
    v_mfma_f32_32x32x16_bf16 v[172:187], v[12:15], v[188:191], 0
    s_nop 0
    v_cndmask_b32_e64 v216, v19, v19, s[38:39]
    v_mov_b32 v140, v216
    v_mov_b32 v141, v216
    v_mov_b32 v142, v216
    v_mov_b32 v143, v216
    v_mov_b32 v144, v216
    v_mov_b32 v145, v216
    v_mov_b32 v146, v216
    v_mov_b32 v147, v216
    v_mov_b32 v148, v216
    v_mov_b32 v149, v216
    v_mov_b32 v150, v216
    v_mov_b32 v151, v216
    v_mov_b32 v152, v216
    v_mov_b32 v153, v216
    v_mov_b32 v154, v216
    v_mov_b32 v155, v216
    v_cvt_pk_bf16_f32 v192, v172, v173
    v_cvt_pk_bf16_f32 v193, v174, v175
    v_cvt_pk_bf16_f32 v194, v176, v177
    v_cvt_pk_bf16_f32 v195, v178, v179
    v_cndmask_b32_e64 v217, v8, v7, s[38:39]
    v_and_b32 v192, v192, v217
    v_and_b32 v193, v193, v217
    v_and_b32 v194, v194, v217
    v_and_b32 v195, v195, v217
    v_cndmask_b32_e64 v208, v184, v180, s[38:39]
    v_cndmask_b32_e64 v209, v185, v181, s[38:39]
    v_cndmask_b32_e64 v210, v186, v182, s[38:39]
    v_cndmask_b32_e64 v211, v187, v183, s[38:39]
    v_mfma_f32_32x32x16_bf16 v[108:123], v[36:39], v[192:195], v[140:155]
    v_mfma_f32_32x32x16_bf16 v[124:139], v[40:43], v[192:195], v[140:155]
    s_waitcnt vmcnt(0)
    s_nop 15
    s_branch L_after_11
L_fb_12:
    s_nop 15
    s_waitcnt vmcnt(0)
    s_add_u32 s46, s28, 5888
    buffer_load_dwordx4 v[188:191], v3, s[4:7], s46 offen
    s_waitcnt vmcnt(0)
    v_cmp_le_u32 s[38:39], 16, v1
    v_mfma_f32_32x32x16_bf16 v[172:187], v[12:15], v[188:191], 0
    s_nop 11
    v_cvt_pk_bf16_f32 v192, v172, v173
    v_cvt_pk_bf16_f32 v193, v174, v175
    v_cvt_pk_bf16_f32 v194, v176, v177
    v_cvt_pk_bf16_f32 v195, v178, v179
    v_cndmask_b32_e64 v217, v8, v7, s[38:39]
    v_and_b32 v192, v192, v217
    v_and_b32 v193, v193, v217
    v_and_b32 v194, v194, v217
    v_and_b32 v195, v195, v217
    v_cndmask_b32_e64 v208, v184, v180, s[38:39]
    v_cndmask_b32_e64 v209, v185, v181, s[38:39]
    v_cndmask_b32_e64 v210, v186, v182, s[38:39]
    v_cndmask_b32_e64 v211, v187, v183, s[38:39]
    v_mfma_f32_32x32x16_bf16 v[108:123], v[36:39], v[192:195], 0
    v_mfma_f32_32x32x16_bf16 v[124:139], v[40:43], v[192:195], 0
    v_mfma_f32_32x32x16_bf16 v[140:155], v[44:47], v[192:195], 0
    v_mfma_f32_32x32x16_bf16 v[156:171], v[48:51], v[192:195], 0
    s_nop 8
    v_max3_f32 v214, v108, v109, v110
    v_max3_f32 v215, v111, v112, v113
    v_max3_f32 v214, v214, v114, v115
    v_max3_f32 v215, v215, v116, v117
    v_max3_f32 v214, v214, v118, v119
    v_max3_f32 v215, v215, v120, v121
    v_max3_f32 v214, v214, v122, v123
    v_max3_f32 v215, v215, v124, v125
    v_max3_f32 v214, v214, v126, v127
    v_max3_f32 v215, v215, v128, v129
    v_max3_f32 v214, v214, v130, v131
    v_max3_f32 v215, v215, v132, v133
    v_max3_f32 v214, v214, v134, v135
    v_max3_f32 v215, v215, v136, v137
    v_max3_f32 v214, v214, v138, v139
    v_max3_f32 v215, v215, v140, v141
    v_max3_f32 v214, v214, v142, v143
    v_max3_f32 v215, v215, v144, v145
    v_max3_f32 v214, v214, v146, v147
    v_max3_f32 v215, v215, v148, v149
    v_max3_f32 v214, v214, v150, v151
    v_max3_f32 v215, v215, v152, v153
    v_max3_f32 v214, v214, v154, v155
    v_max3_f32 v215, v215, v156, v157
    v_max3_f32 v214, v214, v158, v159
    v_max_f32 v214, v214, v215
    v_mov_b32 v215, v214
    s_nop 1
    v_permlane32_swap_b32 v214, v215
    v_max_f32 v214, v214, v215
    v_mul_f32 v140, -1.0, v214
    v_mul_f32 v141, -1.0, v214
    v_mul_f32 v142, -1.0, v214
    v_mul_f32 v143, -1.0, v214
    v_mul_f32 v144, -1.0, v214
    v_mul_f32 v145, -1.0, v214
    v_mul_f32 v146, -1.0, v214
    v_mul_f32 v147, -1.0, v214
    v_mul_f32 v148, -1.0, v214
    v_mul_f32 v149, -1.0, v214
    v_mul_f32 v150, -1.0, v214
    v_mul_f32 v151, -1.0, v214
    v_mul_f32 v152, -1.0, v214
    v_mul_f32 v153, -1.0, v214
    v_mul_f32 v154, -1.0, v214
    v_mul_f32 v155, -1.0, v214
    s_nop 1
    v_mfma_f32_32x32x16_bf16 v[108:123], v[36:39], v[192:195], v[140:155]
    v_mfma_f32_32x32x16_bf16 v[124:139], v[40:43], v[192:195], v[140:155]
    s_nop 10
    v_exp_f32 v108, v108
    v_exp_f32 v109, v109
    v_exp_f32 v110, v110
    v_exp_f32 v111, v111
    v_exp_f32 v112, v112
    v_exp_f32 v113, v113
    v_exp_f32 v114, v114
    v_exp_f32 v115, v115
    v_cvt_pk_bf16_f32 v196, v108, v109
    v_cvt_pk_bf16_f32 v197, v110, v111
    v_cvt_pk_bf16_f32 v198, v112, v113
    v_cvt_pk_bf16_f32 v199, v114, v115
    s_nop 1
    v_mfma_f32_32x32x16_bf16 v[156:171], v[80:83], v[196:199], 0
    v_exp_f32 v116, v116
    v_exp_f32 v117, v117
    v_exp_f32 v118, v118
    v_exp_f32 v119, v119
    v_exp_f32 v120, v120
    v_exp_f32 v121, v121
    v_exp_f32 v122, v122
    v_exp_f32 v123, v123
    v_cvt_pk_bf16_f32 v200, v116, v117
    v_cvt_pk_bf16_f32 v201, v118, v119
    v_cvt_pk_bf16_f32 v202, v120, v121
    v_cvt_pk_bf16_f32 v203, v122, v123
    s_nop 1
    v_mfma_f32_32x32x16_bf16 v[156:171], v[84:87], v[200:203], v[156:171]
    v_mfma_f32_32x32x16_bf16 v[108:123], v[44:47], v[192:195], v[140:155]
    v_exp_f32 v124, v124
    v_exp_f32 v125, v125
    v_exp_f32 v126, v126
    v_exp_f32 v127, v127
    v_exp_f32 v128, v128
    v_exp_f32 v129, v129
    v_exp_f32 v130, v130
    v_exp_f32 v131, v131
    v_cvt_pk_bf16_f32 v196, v124, v125
    v_cvt_pk_bf16_f32 v197, v126, v127
    v_cvt_pk_bf16_f32 v198, v128, v129
    v_cvt_pk_bf16_f32 v199, v130, v131
    s_nop 1
    v_mfma_f32_32x32x16_bf16 v[156:171], v[88:91], v[196:199], v[156:171]
    v_exp_f32 v132, v132
    v_exp_f32 v133, v133
    v_exp_f32 v134, v134
    v_exp_f32 v135, v135
    v_exp_f32 v136, v136
    v_exp_f32 v137, v137
    v_exp_f32 v138, v138
    v_exp_f32 v139, v139
    v_cvt_pk_bf16_f32 v200, v132, v133
    v_cvt_pk_bf16_f32 v201, v134, v135
    v_cvt_pk_bf16_f32 v202, v136, v137
    v_cvt_pk_bf16_f32 v203, v138, v139
    s_nop 1
    v_mfma_f32_32x32x16_bf16 v[156:171], v[92:95], v[200:203], v[156:171]
    v_mfma_f32_32x32x16_bf16 v[124:139], v[48:51], v[192:195], v[140:155]
    v_exp_f32 v108, v108
    v_exp_f32 v109, v109
    v_exp_f32 v110, v110
    v_exp_f32 v111, v111
    v_exp_f32 v112, v112
    v_exp_f32 v113, v113
    v_exp_f32 v114, v114
    v_exp_f32 v115, v115
    v_cvt_pk_bf16_f32 v196, v108, v109
    v_cvt_pk_bf16_f32 v197, v110, v111
    v_cvt_pk_bf16_f32 v198, v112, v113
    v_cvt_pk_bf16_f32 v199, v114, v115
    s_nop 1
    v_mfma_f32_32x32x16_bf16 v[156:171], v[96:99], v[196:199], v[156:171]
    v_exp_f32 v116, v116
    v_exp_f32 v117, v117
    v_exp_f32 v118, v118
    v_exp_f32 v119, v119
    v_exp_f32 v120, v120
    v_exp_f32 v121, v121
    v_exp_f32 v122, v122
    v_exp_f32 v123, v123
    v_cvt_pk_bf16_f32 v200, v116, v117
    v_cvt_pk_bf16_f32 v201, v118, v119
    v_cvt_pk_bf16_f32 v202, v120, v121
    v_cvt_pk_bf16_f32 v203, v122, v123
    s_nop 1
    v_mfma_f32_32x32x16_bf16 v[156:171], v[100:103], v[200:203], v[156:171]
    v_exp_f32 v124, v124
    v_exp_f32 v125, v125
    v_exp_f32 v126, v126
    v_exp_f32 v127, v127
    v_cvt_pk_bf16_f32 v196, v124, v125
    v_cvt_pk_bf16_f32 v197, v126, v127
    v_mov_b32 v198, 0
    v_mov_b32 v199, 0
    s_nop 1
    v_mfma_f32_32x32x16_bf16 v[156:171], v[104:107], v[196:199], v[156:171]
    s_nop 11
    v_rcp_f32 v216, v164
    v_cndmask_b32_e64 v212, v160, v156, s[38:39]
    v_cndmask_b32_e64 v213, v161, v157, s[38:39]
    v_cndmask_b32_e64 v214, v162, v158, s[38:39]
    v_cndmask_b32_e64 v215, v163, v159, s[38:39]
    v_mov_b32 v217, 5888
    v_mov_b32 v218, 0x4001700
    v_cndmask_b32_e64 v217, v217, v218, s[38:39]
    v_add_u32 v217, v5, v217
    v_fma_f32 v212, v212, v216, v208
    v_fma_f32 v213, v213, v216, v209
    v_fma_f32 v214, v214, v216, v210
    v_fma_f32 v215, v215, v216, v211
    v_cvt_pk_bf16_f32 v212, v212, v213
    v_cvt_pk_bf16_f32 v213, v214, v215
    v_pk_max_i16 v212, v212, 0
    v_pk_max_i16 v213, v213, 0
    buffer_store_dwordx2 v[212:213], v217, s[8:11], s28 offen offset:16
    s_waitcnt vmcnt(0)
    s_nop 15
    s_branch L_after_12
.section .rodata,"a"
.p2align 6
.amdhsa_kernel standalone__attention_interact_autoint__recsys_kernel
  .amdhsa_next_free_vgpr 248
  .amdhsa_next_free_sgpr 102
  .amdhsa_accum_offset 248
  .amdhsa_group_segment_fixed_size 0
  .amdhsa_kernarg_size 64
  .amdhsa_user_sgpr_count 2
  .amdhsa_user_sgpr_kernarg_segment_ptr 1
  .amdhsa_system_sgpr_workgroup_id_x 1
.end_amdhsa_kernel
```
